```python
import torch

def _softmax(x, axis=-1):
    return torch.softmax(x, dim=axis)
def _gelu(x):
    return torch.nn.functional.gelu(x, approximate="tanh")
def _silu(x):
    return torch.nn.functional.silu(x)
def _sigmoid(x):
    return torch.sigmoid(x)
def _layernorm(x, axis=-1, eps=1e-5):
    m = x.mean(dim=axis, keepdim=True)
    v = x.var(dim=axis, keepdim=True, unbiased=False)
    return (x - m) / torch.sqrt(v + eps)
def _scatter_add(tgt, idx, src, axis=0):
    return tgt.clone().index_add_(axis, idx, src)
def _segment_sum(src, seg, n):
    out = torch.zeros((n,) + src.shape[1:], dtype=src.dtype)
    return out.index_add_(0, seg, src)
def _pad(x, pw):
    flat = tuple(v for pair in reversed(pw) for v in pair)
    return torch.nn.functional.pad(x, flat)

kernel_name = 'standalone__linear_kernel_rfa__decode'

def setup_inputs():

    _w = (lambda a: (lambda t: t.to(torch.bfloat16) if t.is_floating_point() else t)(torch.as_tensor(a)))
    B, H, Sq, Sk, D, M = 4, 32, 1, 8192, 128, 64
    return {
        "q": _w((lambda *s: torch.randn(*s, dtype=torch.bfloat16) * 0.4)(B, H, Sq, D)),
        "k": _w((lambda *s: torch.randn(*s, dtype=torch.bfloat16) * 1.6)(B, H, Sk, D)),
        "v": _w((lambda *s: torch.randn(*s, dtype=torch.bfloat16) * 1.6)(B, H, Sk, D)),
        "omega": _w((lambda *s: torch.randn(*s, dtype=torch.bfloat16) * 1.6)(M, D)),
    }

def reference(q, k, v, omega):
    d = q.shape[-1]
    m = omega.shape[0]
    scale = float(d) ** -0.25
    qs = q * scale
    ks = k * scale
    q_proj = torch.einsum("bhsd,md->bhsm", qs, omega)
    k_proj = torch.einsum("bhsd,md->bhsm", ks, omega)
    q_sq = 0.5 * torch.einsum("bhsd,bhsd->bhs", qs, qs)[..., None]
    k_sq = 0.5 * torch.einsum("bhsd,bhsd->bhs", ks, ks)[..., None]
    inv_sqrt_m = float(m) ** -0.5
    phi_q = torch.exp(q_proj - q_sq) * inv_sqrt_m + 1e-6
    phi_k = torch.exp(k_proj - k_sq) * inv_sqrt_m + 1e-6
    kv = torch.einsum("bhsm,bhsd->bhmd", phi_k, v)
    z  = torch.einsum("bhsm->bhm", phi_k)
    num = torch.einsum("bhqm,bhmd->bhqd", phi_q, kv)
    den = torch.einsum("bhqm,bhm->bhq", phi_q, z)[..., None] + 1e-6
    return num / den
```

```asm
; @launch grid=(256,1,1) block=(512,1,1) lds=135392
.amdgcn_target "amdgcn-amd-amdhsa--gfx950"
.text
.globl standalone__linear_kernel_rfa__decode_kernel
.p2align 8
.type standalone__linear_kernel_rfa__decode_kernel,@function
standalone__linear_kernel_rfa__decode_kernel:
    s_cmp_ge_u32 s2, 256
    s_cbranch_scc1 L_done
    s_load_dwordx8 s[4:11], s[0:1], 0
    s_load_dwordx4 s[28:31], s[0:1], 32
    s_load_dwordx2 s[32:33], s[0:1], 48
    v_lshrrev_b32 v56, 6, v0
    v_and_b32 v0, 63, v0
    v_readfirstlane_b32 s3, v56
    v_and_b32 v57, 15, v0
    v_lshrrev_b32 v58, 4, v0
    v_mov_b32 v68, v57
    v_lshlrev_b32 v1, 8, v58
    v_lshl_add_u32 v1, v68, 4, v1
    v_lshlrev_b32 v59, 4, v58
    s_lshr_b32 s38, s2, 1
    s_and_b32 s39, s38, 1
    s_xor_b32 s38, s38, s2
    s_and_b32 s38, s38, 1
    s_lshl_b32 s38, s38, 1
    s_andn2_b32 s2, s2, 3
    s_or_b32 s2, s2, s38
    s_or_b32 s2, s2, s39
    s_lshr_b32 s24, s2, 1
    s_lshl_b32 s25, s3, 12
    s_lshl_b32 s39, s2, 20
    v_add_u32 v60, 0, v58
    v_xor_b32 v60, v60, v57
    v_lshlrev_b32 v60, 4, v60
    v_lshl_add_u32 v60, v58, 8, v60
    v_add_u32 v61, 4, v58
    v_xor_b32 v61, v61, v57
    v_lshlrev_b32 v61, 4, v61
    v_lshl_add_u32 v61, v58, 8, v61
    v_add_u32 v62, 8, v58
    v_xor_b32 v62, v62, v57
    v_lshlrev_b32 v62, 4, v62
    v_lshl_add_u32 v62, v58, 8, v62
    v_add_u32 v63, 12, v58
    v_xor_b32 v63, v63, v57
    v_lshlrev_b32 v63, 4, v63
    v_lshl_add_u32 v63, v58, 8, v63
    v_mov_b32 v12, v60
    v_mov_b32 v13, v61
    v_and_b32 v14, 4, v57
    v_add3_u32 v14, v14, v58, 8
    v_xor_b32 v70, v14, v57
    v_lshlrev_b32 v14, 8, v14
    v_lshl_add_u32 v14, v70, 4, v14
    v_and_b32 v15, 4, v57
    v_xor_b32 v15, 4, v15
    v_add3_u32 v15, v15, v58, 8
    v_xor_b32 v70, v15, v57
    v_lshlrev_b32 v15, 8, v15
    v_lshl_add_u32 v15, v70, 4, v15
    v_subrev_u32 v15, 1024, v15
    s_mul_i32 s52, s3, 12288
    s_add_u32 s52, s52, 16384
    s_add_u32 s53, s52, 4096
    s_waitcnt lgkmcnt(0)
    s_add_u32 s12, s8, s39
    s_addc_u32 s13, s9, 0
    s_and_b32 s13, s13, 0xffff
    s_mov_b32 s14, 1048576
    s_mov_b32 s15, 0x20000
    s_mov_b32 s16, s10
    s_and_b32 s17, s11, 0xffff
    s_mov_b32 s18, 16384
    s_mov_b32 s19, 0x20000
    s_add_u32 s8, s6, s39
    s_addc_u32 s9, s7, 0
    s_and_b32 s9, s9, 0xffff
    s_mov_b32 s10, 1048576
    s_mov_b32 s11, 0x20000
    s_mov_b32 s20, s4
    s_and_b32 s21, s5, 0xffff
    s_mov_b32 s22, 32768
    s_mov_b32 s23, 0x20000
    s_cmp_lg_u32 s3, 7
    s_cbranch_scc1 L_norst
    v_mov_b32 v68, 0
    v_mov_b32 v69, 0
    v_mov_b32 v70, 0
    v_mov_b32 v71, 0
    s_lshl_b32 s38, s2, 10
    v_lshl_add_u32 v72, v0, 4, s38
    global_store_dwordx4 v72, v[68:71], s[32:33] sc0 sc1
L_norst:
    s_cmp_ge_u32 s3, 4
    s_cbranch_scc1 L_noom
    s_lshl_b32 s39, s3, 12
    s_mov_b32 m0, s39
    s_nop 0
    buffer_load_dwordx4 v60, s[16:19], s39 offen offset:0 lds
    buffer_load_dwordx4 v61, s[16:19], s39 offen offset:1024 lds
    buffer_load_dwordx4 v62, s[16:19], s39 offen offset:2048 lds
    buffer_load_dwordx4 v63, s[16:19], s39 offen offset:3072 lds
    s_cmp_lg_u32 s3, 0
    s_cbranch_scc1 L_noom
    s_lshl_b32 s38, s24, 8
    buffer_load_dwordx4 v[28:31], v59, s[20:23], s38 offen offset:0
    buffer_load_dwordx4 v[32:35], v59, s[20:23], s38 offen offset:64
    buffer_load_dwordx4 v[36:39], v59, s[20:23], s38 offen offset:128
    buffer_load_dwordx4 v[40:43], v59, s[20:23], s38 offen offset:192
L_noom:
    s_mov_b32 s54, s3
    s_add_u32 s55, s3, 8
    s_add_u32 s56, s3, 16
    s_lshl_b32 s59, s54, 12
    s_mov_b32 m0, s52
    s_nop 0
    buffer_load_dwordx4 v12, s[8:11], s59 offen offset:0 nt lds
    buffer_load_dwordx4 v13, s[8:11], s59 offen offset:1024 nt lds
    s_add_u32 m0, m0, 2048
    s_nop 0
    buffer_load_dwordx4 v14, s[8:11], s59 offen offset:0 nt lds
    buffer_load_dwordx4 v15, s[8:11], s59 offen offset:1024 nt lds
    s_lshl_b32 s59, s55, 12
    s_mov_b32 m0, s53
    s_nop 0
    buffer_load_dwordx4 v12, s[8:11], s59 offen offset:0 nt lds
    buffer_load_dwordx4 v13, s[8:11], s59 offen offset:1024 nt lds
    s_add_u32 m0, m0, 2048
    s_nop 0
    buffer_load_dwordx4 v14, s[8:11], s59 offen offset:0 nt lds
    buffer_load_dwordx4 v15, s[8:11], s59 offen offset:1024 nt lds
    s_lshl_b32 s59, s56, 12
    s_add_u32 m0, s52, 8192
    s_nop 0
    buffer_load_dwordx4 v12, s[8:11], s59 offen offset:0 nt lds
    buffer_load_dwordx4 v13, s[8:11], s59 offen offset:1024 nt lds
    s_add_u32 m0, m0, 2048
    s_nop 0
    buffer_load_dwordx4 v14, s[8:11], s59 offen offset:0 nt lds
    buffer_load_dwordx4 v15, s[8:11], s59 offen offset:1024 nt lds
    s_mov_b32 s34, 0x3e9837f0
    s_mov_b32 s35, 0x3e9837f0
    s_mov_b32 s36, 0x3fb8aa3b
    s_mov_b32 s37, 0x3fb8aa3b
    s_mov_b32 s60, 0x00010001
    s_mov_b32 s61, 0x00010001
    v_mov_b32 v2, 0
    v_mov_b32 v68, 0x0c0c0302
    v_mov_b32 v69, 0x03020c0c
    v_mov_b32 v24, 0x0c0c0c0c
    v_cmp_eq_u32 vcc, 0, v57
    s_nop 1
    v_cndmask_b32 v24, v24, v68, vcc
    v_cmp_eq_u32 vcc, 1, v57
    s_nop 1
    v_cndmask_b32 v24, v24, v69, vcc
    v_mov_b32 v25, 0x0c0c0c0c
    v_cmp_eq_u32 vcc, 2, v57
    s_nop 1
    v_cndmask_b32 v25, v25, v68, vcc
    v_cmp_eq_u32 vcc, 3, v57
    s_nop 1
    v_cndmask_b32 v25, v25, v69, vcc
    v_mov_b32 v26, 0x0c0c0c0c
    v_cmp_eq_u32 vcc, 4, v57
    s_nop 1
    v_cndmask_b32 v26, v26, v68, vcc
    v_cmp_eq_u32 vcc, 5, v57
    s_nop 1
    v_cndmask_b32 v26, v26, v69, vcc
    v_mov_b32 v27, 0x0c0c0c0c
    v_cmp_eq_u32 vcc, 6, v57
    s_nop 1
    v_cndmask_b32 v27, v27, v68, vcc
    v_cmp_eq_u32 vcc, 7, v57
    s_nop 1
    v_cndmask_b32 v27, v27, v69, vcc
    v_mov_b32 v6, 1.0
    v_mov_b32 v7, 0x3f800000
    v_lshl_add_u32 v70, v58, 2, 0
    v_cmp_eq_u32 vcc, v70, v57
    s_nop 1
    v_cndmask_b32 v20, 0, v6, vcc
    v_lshl_add_u32 v70, v58, 2, 1
    v_cmp_eq_u32 vcc, v70, v57
    s_nop 1
    v_cndmask_b32 v21, 0, v6, vcc
    v_lshl_add_u32 v70, v58, 2, 2
    v_cmp_eq_u32 vcc, v70, v57
    s_nop 1
    v_cndmask_b32 v22, 0, v6, vcc
    v_lshl_add_u32 v70, v58, 2, 3
    v_cmp_eq_u32 vcc, v70, v57
    s_nop 1
    v_cndmask_b32 v23, 0, v6, vcc
    v_mov_b32 v10, 135200
    v_mov_b32 v11, 1
    v_lshlrev_b32 v9, 2, v58
    v_add_u32 v9, 114688, v9
    v_add_u32 v16, 0, v58
    v_xor_b32 v16, v16, v57
    v_lshlrev_b32 v16, 4, v16
    v_lshl_add_u32 v16, v57, 8, v16
    v_add_u32 v17, 4, v58
    v_xor_b32 v17, v17, v57
    v_lshlrev_b32 v17, 4, v17
    v_lshl_add_u32 v17, v57, 8, v17
    v_add_u32 v18, 8, v58
    v_xor_b32 v18, v18, v57
    v_lshlrev_b32 v18, 4, v18
    v_lshl_add_u32 v18, v57, 8, v18
    v_add_u32 v19, 12, v58
    v_xor_b32 v19, v19, v57
    v_lshlrev_b32 v19, 4, v19
    v_lshl_add_u32 v19, v57, 8, v19
    s_cmp_lg_u32 s3, 0
    s_cbranch_scc1 L_nz
    v_mov_b32 v60, 0
    v_mov_b32 v61, 0
    v_mov_b32 v62, 24
    v_mov_b32 v63, 0
    ds_write_b128 v10, v[60:63]
L_nz:
    s_cmp_ge_u32 s3, 4
    s_cbranch_scc1 L_yb
    s_waitcnt vmcnt(12) lgkmcnt(0)
    s_barrier
    s_branch L_ob
L_yb:
    s_barrier
L_ob:
    s_cmp_lg_u32 s3, 7
    s_cbranch_scc1 L_noann
    s_waitcnt vmcnt(12)
    s_and_b32 s38, s2, 31
    s_lshl_b32 s38, 1, s38
    s_lshr_b32 s39, s2, 5
    s_lshl_b32 s39, s39, 5
    v_mov_b32 v68, s38
    v_mov_b32 v69, s39
    s_mov_b64 exec, 1
    global_atomic_or v69, v68, s[30:31]
    s_mov_b64 exec, -1
L_noann:
    ds_read_b128 a[0:3], v16 offset:0
    ds_read_b128 a[4:7], v17 offset:0
    ds_read_b128 a[8:11], v18 offset:0
    ds_read_b128 a[12:15], v19 offset:0
    ds_read_b128 a[16:19], v16 offset:4096
    ds_read_b128 a[20:23], v17 offset:4096
    ds_read_b128 a[24:27], v18 offset:4096
    ds_read_b128 a[28:31], v19 offset:4096
    ds_read_b128 a[32:35], v16 offset:8192
    ds_read_b128 a[36:39], v17 offset:8192
    ds_read_b128 a[40:43], v18 offset:8192
    ds_read_b128 a[44:47], v19 offset:8192
    ds_read_b128 a[48:51], v16 offset:12288
    ds_read_b128 a[52:55], v17 offset:12288
    ds_read_b128 a[56:59], v18 offset:12288
    ds_read_b128 a[60:63], v19 offset:12288
    v_and_b32 v68, 15, v0
    v_cmp_lt_u32 vcc, 7, v68
    v_and_b32 v68, 4, v68
    v_lshlrev_b32 v68, 8, v68
    v_sub_u32 v69, 0, v68
    v_cndmask_b32 v69, 0, v69, vcc
    v_sub_u32 v70, 1024, v68
    v_cndmask_b32 v70, 0, v70, vcc
    v_add3_u32 v16, v16, v69, s52
    v_add3_u32 v17, v17, v70, s52
    v_add3_u32 v18, v18, v69, s52
    v_add3_u32 v19, v19, v70, s52
    s_waitcnt vmcnt(8)
    ds_read_b128 v[92:95], v16 offset:0
    ds_read_b128 v[96:99], v17 offset:0
    ds_read_b128 v[100:103], v18 offset:0
    ds_read_b128 v[104:107], v19 offset:0
    s_mov_b64 exec, 1
    ds_add_rtn_u32 v8, v10, v11 offset:8
    s_mov_b64 exec, -1
    s_cmp_lt_u32 s3, 1
    s_cselect_b32 s66, 1, 0
    s_cbranch_scc1 L_doq
    s_waitcnt lgkmcnt(0)
    v_readfirstlane_b32 s57, v8
    s_lshl_b32 s59, s57, 12
    s_mov_b32 m0, s52
    s_nop 0
    buffer_load_dwordx4 v12, s[8:11], s59 offen offset:0 nt lds
    buffer_load_dwordx4 v13, s[8:11], s59 offen offset:1024 nt lds
    s_add_u32 m0, m0, 2048
    s_nop 0
    buffer_load_dwordx4 v14, s[8:11], s59 offen offset:0 nt lds
    buffer_load_dwordx4 v15, s[8:11], s59 offen offset:1024 nt lds
    s_branch L_qdone
L_doq:
    v_lshlrev_b32 v56, 16, v28
    v_and_b32 v57, 0xffff0000, v28
    v_lshlrev_b32 v58, 16, v29
    v_and_b32 v59, 0xffff0000, v29
    v_mul_f32 v56, s34, v56
    v_mul_f32 v58, s34, v58
    v_mul_f32 v57, s34, v57
    v_mul_f32 v59, s34, v59
    v_cvt_pk_bf16_f32 v28, v56, v57
    v_cvt_pk_bf16_f32 v29, v58, v59
    v_lshlrev_b32 v56, 16, v30
    v_and_b32 v57, 0xffff0000, v30
    v_lshlrev_b32 v58, 16, v31
    v_and_b32 v59, 0xffff0000, v31
    v_mul_f32 v56, s34, v56
    v_mul_f32 v58, s34, v58
    v_mul_f32 v57, s34, v57
    v_mul_f32 v59, s34, v59
    v_cvt_pk_bf16_f32 v30, v56, v57
    v_cvt_pk_bf16_f32 v31, v58, v59
    s_waitcnt lgkmcnt(0)
    v_readfirstlane_b32 s57, v8
    s_lshl_b32 s59, s57, 12
    s_mov_b32 m0, s52
    s_nop 0
    buffer_load_dwordx4 v12, s[8:11], s59 offen offset:0 nt lds
    buffer_load_dwordx4 v13, s[8:11], s59 offen offset:1024 nt lds
    s_add_u32 m0, m0, 2048
    s_nop 0
    buffer_load_dwordx4 v14, s[8:11], s59 offen offset:0 nt lds
    buffer_load_dwordx4 v15, s[8:11], s59 offen offset:1024 nt lds
    v_lshlrev_b32 v56, 16, v32
    v_and_b32 v57, 0xffff0000, v32
    v_lshlrev_b32 v58, 16, v33
    v_and_b32 v59, 0xffff0000, v33
    v_mul_f32 v56, s34, v56
    v_mul_f32 v58, s34, v58
    v_mul_f32 v57, s34, v57
    v_mul_f32 v59, s34, v59
    v_cvt_pk_bf16_f32 v32, v56, v57
    v_cvt_pk_bf16_f32 v33, v58, v59
    v_lshlrev_b32 v56, 16, v34
    v_and_b32 v57, 0xffff0000, v34
    v_lshlrev_b32 v58, 16, v35
    v_and_b32 v59, 0xffff0000, v35
    v_mul_f32 v56, s34, v56
    v_mul_f32 v58, s34, v58
    v_mul_f32 v57, s34, v57
    v_mul_f32 v59, s34, v59
    v_cvt_pk_bf16_f32 v34, v56, v57
    v_cvt_pk_bf16_f32 v35, v58, v59
    v_lshlrev_b32 v56, 16, v36
    v_and_b32 v57, 0xffff0000, v36
    v_lshlrev_b32 v58, 16, v37
    v_and_b32 v59, 0xffff0000, v37
    v_mul_f32 v56, s34, v56
    v_mul_f32 v58, s34, v58
    v_mul_f32 v57, s34, v57
    v_mul_f32 v59, s34, v59
    v_cvt_pk_bf16_f32 v36, v56, v57
    v_cvt_pk_bf16_f32 v37, v58, v59
    v_lshlrev_b32 v56, 16, v38
    v_and_b32 v57, 0xffff0000, v38
    v_lshlrev_b32 v58, 16, v39
    v_and_b32 v59, 0xffff0000, v39
    v_mul_f32 v56, s34, v56
    v_mul_f32 v58, s34, v58
    v_mul_f32 v57, s34, v57
    v_mul_f32 v59, s34, v59
    v_cvt_pk_bf16_f32 v38, v56, v57
    v_cvt_pk_bf16_f32 v39, v58, v59
    v_lshlrev_b32 v56, 16, v40
    v_and_b32 v57, 0xffff0000, v40
    v_lshlrev_b32 v58, 16, v41
    v_and_b32 v59, 0xffff0000, v41
    v_mul_f32 v56, s34, v56
    v_mul_f32 v58, s34, v58
    v_mul_f32 v57, s34, v57
    v_mul_f32 v59, s34, v59
    v_cvt_pk_bf16_f32 v40, v56, v57
    v_cvt_pk_bf16_f32 v41, v58, v59
    v_lshlrev_b32 v56, 16, v42
    v_and_b32 v57, 0xffff0000, v42
    v_lshlrev_b32 v58, 16, v43
    v_and_b32 v59, 0xffff0000, v43
    v_mul_f32 v56, s34, v56
    v_mul_f32 v58, s34, v58
    v_mul_f32 v57, s34, v57
    v_mul_f32 v59, s34, v59
    v_cvt_pk_bf16_f32 v42, v56, v57
    v_cvt_pk_bf16_f32 v43, v58, v59
    s_nop 1
    v_mfma_f32_16x16x32_bf16 v[52:55], v[28:31], v[28:31], 0
    v_mfma_f32_16x16x32_bf16 v[68:71], a[0:3], v[28:31], 0
    v_mfma_f32_16x16x32_bf16 v[72:75], a[16:19], v[28:31], 0
    v_mfma_f32_16x16x32_bf16 v[76:79], a[32:35], v[28:31], 0
    v_mfma_f32_16x16x32_bf16 v[80:83], a[48:51], v[28:31], 0
    v_mfma_f32_16x16x32_bf16 v[52:55], v[32:35], v[32:35], v[52:55]
    v_mfma_f32_16x16x32_bf16 v[68:71], a[4:7], v[32:35], v[68:71]
    v_mfma_f32_16x16x32_bf16 v[72:75], a[20:23], v[32:35], v[72:75]
    v_mfma_f32_16x16x32_bf16 v[76:79], a[36:39], v[32:35], v[76:79]
    v_mfma_f32_16x16x32_bf16 v[80:83], a[52:55], v[32:35], v[80:83]
    v_mfma_f32_16x16x32_bf16 v[52:55], v[36:39], v[36:39], v[52:55]
    v_mfma_f32_16x16x32_bf16 v[68:71], a[8:11], v[36:39], v[68:71]
    v_mfma_f32_16x16x32_bf16 v[72:75], a[24:27], v[36:39], v[72:75]
    v_mfma_f32_16x16x32_bf16 v[76:79], a[40:43], v[36:39], v[76:79]
    v_mfma_f32_16x16x32_bf16 v[80:83], a[56:59], v[36:39], v[80:83]
    v_mfma_f32_16x16x32_bf16 v[52:55], v[40:43], v[40:43], v[52:55]
    v_mfma_f32_16x16x32_bf16 v[68:71], a[12:15], v[40:43], v[68:71]
    v_mfma_f32_16x16x32_bf16 v[72:75], a[28:31], v[40:43], v[72:75]
    v_mfma_f32_16x16x32_bf16 v[76:79], a[44:47], v[40:43], v[76:79]
    v_mfma_f32_16x16x32_bf16 v[80:83], a[60:63], v[40:43], v[80:83]
    s_nop 3
    v_mul_f32 v3, v20, v52
    v_fmac_f32 v3, v21, v53
    v_fmac_f32 v3, v22, v54
    v_fmac_f32 v3, v23, v55
    s_nop 1
    v_mfma_f32_16x16x4_f32 v[44:47], v6, v3, 0
    v_cvt_pk_bf16_f32 v68, 0, v68
    v_cvt_pk_bf16_f32 v69, 0, v69
    v_cvt_pk_bf16_f32 v70, 0, v70
    v_cvt_pk_bf16_f32 v71, 0, v71
    v_cvt_pk_bf16_f32 v72, 0, v72
    v_cvt_pk_bf16_f32 v73, 0, v73
    v_cvt_pk_bf16_f32 v74, 0, v74
    v_cvt_pk_bf16_f32 v75, 0, v75
    v_cvt_pk_bf16_f32 v76, 0, v76
    v_cvt_pk_bf16_f32 v77, 0, v77
    v_cvt_pk_bf16_f32 v78, 0, v78
    v_cvt_pk_bf16_f32 v79, 0, v79
    v_cvt_pk_bf16_f32 v80, 0, v80
    v_cvt_pk_bf16_f32 v81, 0, v81
    v_cvt_pk_bf16_f32 v82, 0, v82
    v_cvt_pk_bf16_f32 v83, 0, v83
    v_cvt_pk_bf16_f32 v4, 0, v44
    v_mul_f32 v4, -0.5, v4
    s_mov_b32 s38, 0x3fb8aa3b
    s_mov_b32 s39, 0x358637bd
    v_add_f32 v68, v68, v4
    v_add_f32 v69, v69, v4
    v_add_f32 v70, v70, v4
    v_add_f32 v71, v71, v4
    v_add_f32 v72, v72, v4
    v_add_f32 v73, v73, v4
    v_add_f32 v74, v74, v4
    v_add_f32 v75, v75, v4
    v_add_f32 v76, v76, v4
    v_add_f32 v77, v77, v4
    v_add_f32 v78, v78, v4
    v_add_f32 v79, v79, v4
    v_add_f32 v80, v80, v4
    v_add_f32 v81, v81, v4
    v_add_f32 v82, v82, v4
    v_add_f32 v83, v83, v4
    v_cvt_pk_bf16_f32 v68, 0, v68
    v_cvt_pk_bf16_f32 v69, 0, v69
    v_cvt_pk_bf16_f32 v70, 0, v70
    v_cvt_pk_bf16_f32 v71, 0, v71
    v_cvt_pk_bf16_f32 v72, 0, v72
    v_cvt_pk_bf16_f32 v73, 0, v73
    v_cvt_pk_bf16_f32 v74, 0, v74
    v_cvt_pk_bf16_f32 v75, 0, v75
    v_cvt_pk_bf16_f32 v76, 0, v76
    v_cvt_pk_bf16_f32 v77, 0, v77
    v_cvt_pk_bf16_f32 v78, 0, v78
    v_cvt_pk_bf16_f32 v79, 0, v79
    v_cvt_pk_bf16_f32 v80, 0, v80
    v_cvt_pk_bf16_f32 v81, 0, v81
    v_cvt_pk_bf16_f32 v82, 0, v82
    v_cvt_pk_bf16_f32 v83, 0, v83
    v_mul_f32 v68, s38, v68
    v_mul_f32 v69, s38, v69
    v_mul_f32 v70, s38, v70
    v_mul_f32 v71, s38, v71
    v_mul_f32 v72, s38, v72
    v_mul_f32 v73, s38, v73
    v_mul_f32 v74, s38, v74
    v_mul_f32 v75, s38, v75
    v_mul_f32 v76, s38, v76
    v_mul_f32 v77, s38, v77
    v_mul_f32 v78, s38, v78
    v_mul_f32 v79, s38, v79
    v_mul_f32 v80, s38, v80
    v_mul_f32 v81, s38, v81
    v_mul_f32 v82, s38, v82
    v_mul_f32 v83, s38, v83
    v_exp_f32 v68, v68
    v_exp_f32 v69, v69
    v_exp_f32 v70, v70
    v_exp_f32 v71, v71
    v_exp_f32 v72, v72
    v_exp_f32 v73, v73
    v_exp_f32 v74, v74
    v_exp_f32 v75, v75
    v_exp_f32 v76, v76
    v_exp_f32 v77, v77
    v_exp_f32 v78, v78
    v_exp_f32 v79, v79
    v_exp_f32 v80, v80
    v_exp_f32 v81, v81
    v_exp_f32 v82, v82
    v_exp_f32 v83, v83
    v_cvt_pk_bf16_f32 v68, 0, v68
    v_cvt_pk_bf16_f32 v69, 0, v69
    v_cvt_pk_bf16_f32 v70, 0, v70
    v_cvt_pk_bf16_f32 v71, 0, v71
    v_cvt_pk_bf16_f32 v72, 0, v72
    v_cvt_pk_bf16_f32 v73, 0, v73
    v_cvt_pk_bf16_f32 v74, 0, v74
    v_cvt_pk_bf16_f32 v75, 0, v75
    v_cvt_pk_bf16_f32 v76, 0, v76
    v_cvt_pk_bf16_f32 v77, 0, v77
    v_cvt_pk_bf16_f32 v78, 0, v78
    v_cvt_pk_bf16_f32 v79, 0, v79
    v_cvt_pk_bf16_f32 v80, 0, v80
    v_cvt_pk_bf16_f32 v81, 0, v81
    v_cvt_pk_bf16_f32 v82, 0, v82
    v_cvt_pk_bf16_f32 v83, 0, v83
    v_mul_f32 v68, 0x3e000000, v68
    v_mul_f32 v69, 0x3e000000, v69
    v_mul_f32 v70, 0x3e000000, v70
    v_mul_f32 v71, 0x3e000000, v71
    v_mul_f32 v72, 0x3e000000, v72
    v_mul_f32 v73, 0x3e000000, v73
    v_mul_f32 v74, 0x3e000000, v74
    v_mul_f32 v75, 0x3e000000, v75
    v_mul_f32 v76, 0x3e000000, v76
    v_mul_f32 v77, 0x3e000000, v77
    v_mul_f32 v78, 0x3e000000, v78
    v_mul_f32 v79, 0x3e000000, v79
    v_mul_f32 v80, 0x3e000000, v80
    v_mul_f32 v81, 0x3e000000, v81
    v_mul_f32 v82, 0x3e000000, v82
    v_mul_f32 v83, 0x3e000000, v83
    v_add_f32 v68, s39, v68
    v_add_f32 v69, s39, v69
    v_add_f32 v70, s39, v70
    v_add_f32 v71, s39, v71
    v_add_f32 v72, s39, v72
    v_add_f32 v73, s39, v73
    v_add_f32 v74, s39, v74
    v_add_f32 v75, s39, v75
    v_add_f32 v76, s39, v76
    v_add_f32 v77, s39, v77
    v_add_f32 v78, s39, v78
    v_add_f32 v79, s39, v79
    v_add_f32 v80, s39, v80
    v_add_f32 v81, s39, v81
    v_add_f32 v82, s39, v82
    v_add_f32 v83, s39, v83
    v_cvt_pk_bf16_f32 v68, 0, v68
    v_cvt_pk_bf16_f32 v69, 0, v69
    v_cvt_pk_bf16_f32 v70, 0, v70
    v_cvt_pk_bf16_f32 v71, 0, v71
    v_cvt_pk_bf16_f32 v72, 0, v72
    v_cvt_pk_bf16_f32 v73, 0, v73
    v_cvt_pk_bf16_f32 v74, 0, v74
    v_cvt_pk_bf16_f32 v75, 0, v75
    v_cvt_pk_bf16_f32 v76, 0, v76
    v_cvt_pk_bf16_f32 v77, 0, v77
    v_cvt_pk_bf16_f32 v78, 0, v78
    v_cvt_pk_bf16_f32 v79, 0, v79
    v_cvt_pk_bf16_f32 v80, 0, v80
    v_cvt_pk_bf16_f32 v81, 0, v81
    v_cvt_pk_bf16_f32 v82, 0, v82
    v_cvt_pk_bf16_f32 v83, 0, v83
    v_add_f32 v3, v68, v69
    v_add_f32 v3, v3, v70
    v_add_f32 v3, v3, v71
    v_add_f32 v3, v3, v72
    v_add_f32 v3, v3, v73
    v_add_f32 v3, v3, v74
    v_add_f32 v3, v3, v75
    v_add_f32 v3, v3, v76
    v_add_f32 v3, v3, v77
    v_add_f32 v3, v3, v78
    v_add_f32 v3, v3, v79
    v_add_f32 v3, v3, v80
    v_add_f32 v3, v3, v81
    v_add_f32 v3, v3, v82
    v_add_f32 v3, v3, v83
    v_mul_f32 v68, 0x3e000000, v68
    v_mul_f32 v69, 0x3e000000, v69
    v_mul_f32 v70, 0x3e000000, v70
    v_mul_f32 v71, 0x3e000000, v71
    v_mul_f32 v72, 0x3e000000, v72
    v_mul_f32 v73, 0x3e000000, v73
    v_mul_f32 v74, 0x3e000000, v74
    v_mul_f32 v75, 0x3e000000, v75
    v_mul_f32 v76, 0x3e000000, v76
    v_mul_f32 v77, 0x3e000000, v77
    v_mul_f32 v78, 0x3e000000, v78
    v_mul_f32 v79, 0x3e000000, v79
    v_mul_f32 v80, 0x3e000000, v80
    v_mul_f32 v81, 0x3e000000, v81
    v_mul_f32 v82, 0x3e000000, v82
    v_mul_f32 v83, 0x3e000000, v83
    v_mul_f32 v3, s39, v3
    v_cvt_pk_bf16_f32 v28, v68, v69
    v_cvt_pk_bf16_f32 v29, v70, v71
    v_cvt_pk_bf16_f32 v30, v72, v73
    v_cvt_pk_bf16_f32 v31, v74, v75
    v_cvt_pk_bf16_f32 v32, v76, v77
    v_cvt_pk_bf16_f32 v33, v78, v79
    v_cvt_pk_bf16_f32 v34, v80, v81
    v_cvt_pk_bf16_f32 v35, v82, v83
    v_mfma_f32_16x16x4_f32 v[36:39], v6, v3, 0
    s_cmp_lg_u32 s3, 0
    s_cbranch_scc1 L_qdone
    v_lshlrev_b32 v56, 1, v0
    v_add_u32 v56, 135232, v56
    s_mov_b64 exec, s[60:61]
    ds_write_b128 v56, v[28:31]
    ds_write_b128 v56, v[32:35] offset:16
    s_mov_b64 exec, 1
    s_nop 4
    ds_write_b128 v10, v[36:39] offset:160
    ds_write_b32 v10, v11 offset:12
    s_mov_b64 exec, -1
L_qdone:
    v_mov_b32 v40, 0
    v_mov_b32 v41, 0
    v_mov_b32 v42, 0
    v_mov_b32 v43, 0
    s_cmp_ge_u32 s3, 4
    s_cselect_b32 s62, 0, 0
    s_mov_b32 s63, 0
    s_mov_b32 s64, 4096
    s_mov_b32 s46, 4096
    v_add_u32 v16, 4096, v16
    v_add_u32 v17, 4096, v17
    v_add_u32 v18, 4096, v18
    v_add_u32 v19, 4096, v19
    .p2align 6
L_kloop:
    s_cmp_ge_u32 s54, 256
    s_cbranch_scc1 L_kdone
    s_waitcnt vmcnt(8)
    ds_read_b128 v[108:111], v16 offset:0
    ds_read_b128 v[112:115], v17 offset:0
    ds_read_b128 v[116:119], v18 offset:0
    ds_read_b128 v[120:123], v19 offset:0
    s_mov_b64 exec, 1
    ds_add_rtn_u32 v8, v10, v11 offset:8
    s_mov_b64 exec, -1
    v_lshlrev_b32 v56, 16, v92
    v_and_b32 v57, 0xffff0000, v92
    v_lshlrev_b32 v58, 16, v93
    v_and_b32 v59, 0xffff0000, v93
    v_mul_f32 v56, s34, v56
    v_mul_f32 v58, s34, v58
    v_mul_f32 v57, s34, v57
    v_mul_f32 v59, s34, v59
    v_cvt_pk_bf16_f32 v92, v56, v57
    v_cvt_pk_bf16_f32 v93, v58, v59
    v_lshlrev_b32 v56, 16, v94
    v_and_b32 v57, 0xffff0000, v94
    v_lshlrev_b32 v58, 16, v95
    v_and_b32 v59, 0xffff0000, v95
    v_mul_f32 v56, s34, v56
    v_mul_f32 v58, s34, v58
    v_mul_f32 v57, s34, v57
    v_mul_f32 v59, s34, v59
    v_cvt_pk_bf16_f32 v94, v56, v57
    v_cvt_pk_bf16_f32 v95, v58, v59
    s_waitcnt lgkmcnt(0)
    v_readfirstlane_b32 s58, v8
    s_lshl_b32 s38, s54, 6
    s_min_u32 s58, s58, 256
    s_lshl_b32 s59, s58, 12
    s_cmp_ge_u32 s58, 256
    s_cbranch_scc1 L_alt0
L_dma0:
    s_add_u32 m0, s52, s64
    s_nop 0
    buffer_load_dwordx4 v12, s[8:11], s59 offen offset:0 nt lds
    buffer_load_dwordx4 v13, s[8:11], s59 offen offset:1024 nt lds
    s_add_u32 m0, m0, 2048
    s_nop 0
    buffer_load_dwordx4 v14, s[8:11], s59 offen offset:0 nt lds
    buffer_load_dwordx4 v15, s[8:11], s59 offen offset:1024 nt lds
    s_add_u32 s63, s63, 1
    s_max_i32 s39, s63, 0
    s_min_u32 s39, s39, 1
    s_cmp_lt_u32 s62, s39
    s_cbranch_scc1 L_pre0
L_back0:
    s_cmp_eq_u32 s64, 8192
    s_cselect_b32 s65, 4294959104, s46
    s_add_u32 s64, s64, s65
    v_add_u32 v16, s65, v16
    v_add_u32 v17, s65, v17
    v_add_u32 v18, s65, v18
    v_add_u32 v19, s65, v19
    v_lshlrev_b32 v56, 16, v96
    v_and_b32 v57, 0xffff0000, v96
    v_lshlrev_b32 v58, 16, v97
    v_and_b32 v59, 0xffff0000, v97
    v_mul_f32 v56, s34, v56
    v_mul_f32 v58, s34, v58
    v_mul_f32 v57, s34, v57
    v_mul_f32 v59, s34, v59
    v_cvt_pk_bf16_f32 v96, v56, v57
    v_cvt_pk_bf16_f32 v97, v58, v59
    v_lshlrev_b32 v56, 16, v98
    v_and_b32 v57, 0xffff0000, v98
    v_lshlrev_b32 v58, 16, v99
    v_and_b32 v59, 0xffff0000, v99
    v_mul_f32 v56, s34, v56
    v_mul_f32 v58, s34, v58
    v_mul_f32 v57, s34, v57
    v_mul_f32 v59, s34, v59
    v_cvt_pk_bf16_f32 v98, v56, v57
    v_cvt_pk_bf16_f32 v99, v58, v59
    v_lshlrev_b32 v56, 16, v100
    v_and_b32 v57, 0xffff0000, v100
    v_lshlrev_b32 v58, 16, v101
    v_and_b32 v59, 0xffff0000, v101
    v_mul_f32 v56, s34, v56
    v_mul_f32 v58, s34, v58
    v_mul_f32 v57, s34, v57
    v_mul_f32 v59, s34, v59
    v_cvt_pk_bf16_f32 v100, v56, v57
    v_cvt_pk_bf16_f32 v101, v58, v59
    v_lshlrev_b32 v56, 16, v102
    v_and_b32 v57, 0xffff0000, v102
    v_lshlrev_b32 v58, 16, v103
    v_and_b32 v59, 0xffff0000, v103
    v_mul_f32 v56, s34, v56
    v_mul_f32 v58, s34, v58
    v_mul_f32 v57, s34, v57
    v_mul_f32 v59, s34, v59
    v_cvt_pk_bf16_f32 v102, v56, v57
    v_cvt_pk_bf16_f32 v103, v58, v59
    v_lshlrev_b32 v56, 16, v104
    v_and_b32 v57, 0xffff0000, v104
    v_lshlrev_b32 v58, 16, v105
    v_and_b32 v59, 0xffff0000, v105
    v_mul_f32 v56, s34, v56
    v_mul_f32 v58, s34, v58
    v_mul_f32 v57, s34, v57
    v_mul_f32 v59, s34, v59
    v_cvt_pk_bf16_f32 v104, v56, v57
    v_cvt_pk_bf16_f32 v105, v58, v59
    v_lshlrev_b32 v56, 16, v106
    v_and_b32 v57, 0xffff0000, v106
    v_lshlrev_b32 v58, 16, v107
    v_and_b32 v59, 0xffff0000, v107
    v_mul_f32 v56, s34, v56
    v_mul_f32 v58, s34, v58
    v_mul_f32 v57, s34, v57
    v_mul_f32 v59, s34, v59
    v_cvt_pk_bf16_f32 v106, v56, v57
    v_cvt_pk_bf16_f32 v107, v58, v59
    s_nop 1
    v_mfma_f32_16x16x32_bf16 v[52:55], v[92:95], v[92:95], 0
    v_mfma_f32_16x16x32_bf16 v[68:71], a[0:3], v[92:95], 0
    v_mfma_f32_16x16x32_bf16 v[72:75], a[16:19], v[92:95], 0
    v_mfma_f32_16x16x32_bf16 v[76:79], a[32:35], v[92:95], 0
    v_mfma_f32_16x16x32_bf16 v[80:83], a[48:51], v[92:95], 0
    v_mfma_f32_16x16x32_bf16 v[52:55], v[96:99], v[96:99], v[52:55]
    v_mfma_f32_16x16x32_bf16 v[68:71], a[4:7], v[96:99], v[68:71]
    v_mfma_f32_16x16x32_bf16 v[72:75], a[20:23], v[96:99], v[72:75]
    v_mfma_f32_16x16x32_bf16 v[76:79], a[36:39], v[96:99], v[76:79]
    v_mfma_f32_16x16x32_bf16 v[80:83], a[52:55], v[96:99], v[80:83]
    v_mfma_f32_16x16x32_bf16 v[52:55], v[100:103], v[100:103], v[52:55]
    v_mfma_f32_16x16x32_bf16 v[68:71], a[8:11], v[100:103], v[68:71]
    v_mfma_f32_16x16x32_bf16 v[72:75], a[24:27], v[100:103], v[72:75]
    v_mfma_f32_16x16x32_bf16 v[76:79], a[40:43], v[100:103], v[76:79]
    v_mfma_f32_16x16x32_bf16 v[80:83], a[56:59], v[100:103], v[80:83]
    v_mfma_f32_16x16x32_bf16 v[52:55], v[104:107], v[104:107], v[52:55]
    v_mfma_f32_16x16x32_bf16 v[68:71], a[12:15], v[104:107], v[68:71]
    v_mfma_f32_16x16x32_bf16 v[72:75], a[28:31], v[104:107], v[72:75]
    v_mfma_f32_16x16x32_bf16 v[76:79], a[44:47], v[104:107], v[76:79]
    v_mfma_f32_16x16x32_bf16 v[80:83], a[60:63], v[104:107], v[80:83]
    s_nop 3
    v_mul_f32 v3, v20, v52
    v_fmac_f32 v3, v21, v53
    v_fmac_f32 v3, v22, v54
    v_fmac_f32 v3, v23, v55
    s_nop 1
    v_mfma_f32_16x16x4_f32 v[44:47], v7, v3, 0
    v_cvt_pk_bf16_f32 v68, 0, v68
    v_cvt_pk_bf16_f32 v69, 0, v69
    v_cvt_pk_bf16_f32 v70, 0, v70
    v_cvt_pk_bf16_f32 v71, 0, v71
    v_cvt_pk_bf16_f32 v72, 0, v72
    v_cvt_pk_bf16_f32 v73, 0, v73
    v_cvt_pk_bf16_f32 v74, 0, v74
    v_cvt_pk_bf16_f32 v75, 0, v75
    v_cvt_pk_bf16_f32 v76, 0, v76
    v_cvt_pk_bf16_f32 v77, 0, v77
    v_cvt_pk_bf16_f32 v78, 0, v78
    v_cvt_pk_bf16_f32 v79, 0, v79
    v_cvt_pk_bf16_f32 v80, 0, v80
    v_cvt_pk_bf16_f32 v81, 0, v81
    v_cvt_pk_bf16_f32 v82, 0, v82
    v_cvt_pk_bf16_f32 v83, 0, v83
    v_cvt_pk_bf16_f32 v4, 0, v44
    v_mul_f32 v4, -0.5, v4
    v_pk_add_f32 v[68:69], v[68:69], v[4:5] op_sel_hi:[1,0]
    v_pk_add_f32 v[70:71], v[70:71], v[4:5] op_sel_hi:[1,0]
    v_pk_add_f32 v[72:73], v[72:73], v[4:5] op_sel_hi:[1,0]
    v_pk_add_f32 v[74:75], v[74:75], v[4:5] op_sel_hi:[1,0]
    v_cvt_pk_bf16_f32 v68, 0, v68
    v_cvt_pk_bf16_f32 v69, 0, v69
    v_cvt_pk_bf16_f32 v70, 0, v70
    v_cvt_pk_bf16_f32 v71, 0, v71
    v_cvt_pk_bf16_f32 v72, 0, v72
    v_cvt_pk_bf16_f32 v73, 0, v73
    v_cvt_pk_bf16_f32 v74, 0, v74
    v_cvt_pk_bf16_f32 v75, 0, v75
    v_pk_mul_f32 v[68:69], v[68:69], s[36:37]
    v_pk_mul_f32 v[70:71], v[70:71], s[36:37]
    v_pk_mul_f32 v[72:73], v[72:73], s[36:37]
    v_pk_mul_f32 v[74:75], v[74:75], s[36:37]
    v_exp_f32 v68, v68
    v_exp_f32 v69, v69
    v_exp_f32 v70, v70
    v_exp_f32 v71, v71
    v_exp_f32 v72, v72
    v_exp_f32 v73, v73
    v_exp_f32 v74, v74
    v_exp_f32 v75, v75
    v_cvt_pk_bf16_f32 v60, v68, v69
    v_cvt_pk_bf16_f32 v61, v70, v71
    v_cvt_pk_bf16_f32 v62, v72, v73
    v_cvt_pk_bf16_f32 v63, v74, v75
    v_pk_add_f32 v[76:77], v[76:77], v[4:5] op_sel_hi:[1,0]
    v_pk_add_f32 v[78:79], v[78:79], v[4:5] op_sel_hi:[1,0]
    v_pk_add_f32 v[80:81], v[80:81], v[4:5] op_sel_hi:[1,0]
    v_pk_add_f32 v[82:83], v[82:83], v[4:5] op_sel_hi:[1,0]
    v_cvt_pk_bf16_f32 v76, 0, v76
    v_cvt_pk_bf16_f32 v77, 0, v77
    v_cvt_pk_bf16_f32 v78, 0, v78
    v_cvt_pk_bf16_f32 v79, 0, v79
    v_cvt_pk_bf16_f32 v80, 0, v80
    v_cvt_pk_bf16_f32 v81, 0, v81
    v_cvt_pk_bf16_f32 v82, 0, v82
    v_cvt_pk_bf16_f32 v83, 0, v83
    v_pk_mul_f32 v[76:77], v[76:77], s[36:37]
    v_pk_mul_f32 v[78:79], v[78:79], s[36:37]
    v_pk_mul_f32 v[80:81], v[80:81], s[36:37]
    v_pk_mul_f32 v[82:83], v[82:83], s[36:37]
    v_exp_f32 v76, v76
    v_exp_f32 v77, v77
    v_exp_f32 v78, v78
    v_exp_f32 v79, v79
    v_exp_f32 v80, v80
    v_exp_f32 v81, v81
    v_exp_f32 v82, v82
    v_exp_f32 v83, v83
    v_cvt_pk_bf16_f32 v64, v76, v77
    v_cvt_pk_bf16_f32 v65, v78, v79
    v_cvt_pk_bf16_f32 v66, v80, v81
    v_cvt_pk_bf16_f32 v67, v82, v83
    s_cmp_eq_u32 s66, 0
    s_cbranch_scc1 L_getq0
L_gotq0:
    v_mfma_f32_16x16x32_bf16 v[48:51], v[60:63], v[28:31], v[36:39]
    v_add_u32 v56, s38, v9
    v_mfma_f32_16x16x32_bf16 v[48:51], v[64:67], v[32:35], v[48:51]
    s_mov_b32 s54, s55
    s_mov_b32 s55, s56
    s_mov_b32 s56, s57
    s_mov_b32 s57, s58
    s_nop 4
    v_cvt_pk_bf16_f32 v48, 0, v48
    v_cvt_pk_bf16_f32 v49, 0, v49
    v_cvt_pk_bf16_f32 v50, 0, v50
    v_cvt_pk_bf16_f32 v51, 0, v51
    s_mov_b64 exec, s[60:61]
    ds_write2_b32 v56, v48, v49 offset0:0 offset1:4
    ds_write2_b32 v56, v50, v51 offset0:8 offset1:12
    s_mov_b64 exec, -1
    s_cmp_ge_u32 s54, 256
    s_cbranch_scc1 L_kdone
    s_waitcnt vmcnt(8)
    ds_read_b128 v[92:95], v16 offset:0
    ds_read_b128 v[96:99], v17 offset:0
    ds_read_b128 v[100:103], v18 offset:0
    ds_read_b128 v[104:107], v19 offset:0
    s_mov_b64 exec, 1
    ds_add_rtn_u32 v8, v10, v11 offset:8
    s_mov_b64 exec, -1
    v_lshlrev_b32 v56, 16, v108
    v_and_b32 v57, 0xffff0000, v108
    v_lshlrev_b32 v58, 16, v109
    v_and_b32 v59, 0xffff0000, v109
    v_mul_f32 v56, s34, v56
    v_mul_f32 v58, s34, v58
    v_mul_f32 v57, s34, v57
    v_mul_f32 v59, s34, v59
    v_cvt_pk_bf16_f32 v108, v56, v57
    v_cvt_pk_bf16_f32 v109, v58, v59
    v_lshlrev_b32 v56, 16, v110
    v_and_b32 v57, 0xffff0000, v110
    v_lshlrev_b32 v58, 16, v111
    v_and_b32 v59, 0xffff0000, v111
    v_mul_f32 v56, s34, v56
    v_mul_f32 v58, s34, v58
    v_mul_f32 v57, s34, v57
    v_mul_f32 v59, s34, v59
    v_cvt_pk_bf16_f32 v110, v56, v57
    v_cvt_pk_bf16_f32 v111, v58, v59
    s_waitcnt lgkmcnt(0)
    v_readfirstlane_b32 s58, v8
    s_lshl_b32 s38, s54, 6
    s_min_u32 s58, s58, 256
    s_lshl_b32 s59, s58, 12
    s_cmp_ge_u32 s58, 256
    s_cbranch_scc1 L_alt1
L_dma1:
    s_add_u32 m0, s52, s64
    s_nop 0
    buffer_load_dwordx4 v12, s[8:11], s59 offen offset:0 nt lds
    buffer_load_dwordx4 v13, s[8:11], s59 offen offset:1024 nt lds
    s_add_u32 m0, m0, 2048
    s_nop 0
    buffer_load_dwordx4 v14, s[8:11], s59 offen offset:0 nt lds
    buffer_load_dwordx4 v15, s[8:11], s59 offen offset:1024 nt lds
    s_add_u32 s63, s63, 1
    s_max_i32 s39, s63, 0
    s_min_u32 s39, s39, 1
    s_cmp_lt_u32 s62, s39
    s_cbranch_scc1 L_pre1
L_back1:
    s_cmp_eq_u32 s64, 8192
    s_cselect_b32 s65, 4294959104, s46
    s_add_u32 s64, s64, s65
    v_add_u32 v16, s65, v16
    v_add_u32 v17, s65, v17
    v_add_u32 v18, s65, v18
    v_add_u32 v19, s65, v19
    v_lshlrev_b32 v56, 16, v112
    v_and_b32 v57, 0xffff0000, v112
    v_lshlrev_b32 v58, 16, v113
    v_and_b32 v59, 0xffff0000, v113
    v_mul_f32 v56, s34, v56
    v_mul_f32 v58, s34, v58
    v_mul_f32 v57, s34, v57
    v_mul_f32 v59, s34, v59
    v_cvt_pk_bf16_f32 v112, v56, v57
    v_cvt_pk_bf16_f32 v113, v58, v59
    v_lshlrev_b32 v56, 16, v114
    v_and_b32 v57, 0xffff0000, v114
    v_lshlrev_b32 v58, 16, v115
    v_and_b32 v59, 0xffff0000, v115
    v_mul_f32 v56, s34, v56
    v_mul_f32 v58, s34, v58
    v_mul_f32 v57, s34, v57
    v_mul_f32 v59, s34, v59
    v_cvt_pk_bf16_f32 v114, v56, v57
    v_cvt_pk_bf16_f32 v115, v58, v59
    v_lshlrev_b32 v56, 16, v116
    v_and_b32 v57, 0xffff0000, v116
    v_lshlrev_b32 v58, 16, v117
    v_and_b32 v59, 0xffff0000, v117
    v_mul_f32 v56, s34, v56
    v_mul_f32 v58, s34, v58
    v_mul_f32 v57, s34, v57
    v_mul_f32 v59, s34, v59
    v_cvt_pk_bf16_f32 v116, v56, v57
    v_cvt_pk_bf16_f32 v117, v58, v59
    v_lshlrev_b32 v56, 16, v118
    v_and_b32 v57, 0xffff0000, v118
    v_lshlrev_b32 v58, 16, v119
    v_and_b32 v59, 0xffff0000, v119
    v_mul_f32 v56, s34, v56
    v_mul_f32 v58, s34, v58
    v_mul_f32 v57, s34, v57
    v_mul_f32 v59, s34, v59
    v_cvt_pk_bf16_f32 v118, v56, v57
    v_cvt_pk_bf16_f32 v119, v58, v59
    v_lshlrev_b32 v56, 16, v120
    v_and_b32 v57, 0xffff0000, v120
    v_lshlrev_b32 v58, 16, v121
    v_and_b32 v59, 0xffff0000, v121
    v_mul_f32 v56, s34, v56
    v_mul_f32 v58, s34, v58
    v_mul_f32 v57, s34, v57
    v_mul_f32 v59, s34, v59
    v_cvt_pk_bf16_f32 v120, v56, v57
    v_cvt_pk_bf16_f32 v121, v58, v59
    v_lshlrev_b32 v56, 16, v122
    v_and_b32 v57, 0xffff0000, v122
    v_lshlrev_b32 v58, 16, v123
    v_and_b32 v59, 0xffff0000, v123
    v_mul_f32 v56, s34, v56
    v_mul_f32 v58, s34, v58
    v_mul_f32 v57, s34, v57
    v_mul_f32 v59, s34, v59
    v_cvt_pk_bf16_f32 v122, v56, v57
    v_cvt_pk_bf16_f32 v123, v58, v59
    s_nop 1
    v_mfma_f32_16x16x32_bf16 v[52:55], v[108:111], v[108:111], 0
    v_mfma_f32_16x16x32_bf16 v[68:71], a[0:3], v[108:111], 0
    v_mfma_f32_16x16x32_bf16 v[72:75], a[16:19], v[108:111], 0
    v_mfma_f32_16x16x32_bf16 v[76:79], a[32:35], v[108:111], 0
    v_mfma_f32_16x16x32_bf16 v[80:83], a[48:51], v[108:111], 0
    v_mfma_f32_16x16x32_bf16 v[52:55], v[112:115], v[112:115], v[52:55]
    v_mfma_f32_16x16x32_bf16 v[68:71], a[4:7], v[112:115], v[68:71]
    v_mfma_f32_16x16x32_bf16 v[72:75], a[20:23], v[112:115], v[72:75]
    v_mfma_f32_16x16x32_bf16 v[76:79], a[36:39], v[112:115], v[76:79]
    v_mfma_f32_16x16x32_bf16 v[80:83], a[52:55], v[112:115], v[80:83]
    v_mfma_f32_16x16x32_bf16 v[52:55], v[116:119], v[116:119], v[52:55]
    v_mfma_f32_16x16x32_bf16 v[68:71], a[8:11], v[116:119], v[68:71]
    v_mfma_f32_16x16x32_bf16 v[72:75], a[24:27], v[116:119], v[72:75]
    v_mfma_f32_16x16x32_bf16 v[76:79], a[40:43], v[116:119], v[76:79]
    v_mfma_f32_16x16x32_bf16 v[80:83], a[56:59], v[116:119], v[80:83]
    v_mfma_f32_16x16x32_bf16 v[52:55], v[120:123], v[120:123], v[52:55]
    v_mfma_f32_16x16x32_bf16 v[68:71], a[12:15], v[120:123], v[68:71]
    v_mfma_f32_16x16x32_bf16 v[72:75], a[28:31], v[120:123], v[72:75]
    v_mfma_f32_16x16x32_bf16 v[76:79], a[44:47], v[120:123], v[76:79]
    v_mfma_f32_16x16x32_bf16 v[80:83], a[60:63], v[120:123], v[80:83]
    s_nop 3
    v_mul_f32 v3, v20, v52
    v_fmac_f32 v3, v21, v53
    v_fmac_f32 v3, v22, v54
    v_fmac_f32 v3, v23, v55
    s_nop 1
    v_mfma_f32_16x16x4_f32 v[44:47], v7, v3, 0
    v_cvt_pk_bf16_f32 v68, 0, v68
    v_cvt_pk_bf16_f32 v69, 0, v69
    v_cvt_pk_bf16_f32 v70, 0, v70
    v_cvt_pk_bf16_f32 v71, 0, v71
    v_cvt_pk_bf16_f32 v72, 0, v72
    v_cvt_pk_bf16_f32 v73, 0, v73
    v_cvt_pk_bf16_f32 v74, 0, v74
    v_cvt_pk_bf16_f32 v75, 0, v75
    v_cvt_pk_bf16_f32 v76, 0, v76
    v_cvt_pk_bf16_f32 v77, 0, v77
    v_cvt_pk_bf16_f32 v78, 0, v78
    v_cvt_pk_bf16_f32 v79, 0, v79
    v_cvt_pk_bf16_f32 v80, 0, v80
    v_cvt_pk_bf16_f32 v81, 0, v81
    v_cvt_pk_bf16_f32 v82, 0, v82
    v_cvt_pk_bf16_f32 v83, 0, v83
    v_cvt_pk_bf16_f32 v4, 0, v44
    v_mul_f32 v4, -0.5, v4
    v_pk_add_f32 v[68:69], v[68:69], v[4:5] op_sel_hi:[1,0]
    v_pk_add_f32 v[70:71], v[70:71], v[4:5] op_sel_hi:[1,0]
    v_pk_add_f32 v[72:73], v[72:73], v[4:5] op_sel_hi:[1,0]
    v_pk_add_f32 v[74:75], v[74:75], v[4:5] op_sel_hi:[1,0]
    v_cvt_pk_bf16_f32 v68, 0, v68
    v_cvt_pk_bf16_f32 v69, 0, v69
    v_cvt_pk_bf16_f32 v70, 0, v70
    v_cvt_pk_bf16_f32 v71, 0, v71
    v_cvt_pk_bf16_f32 v72, 0, v72
    v_cvt_pk_bf16_f32 v73, 0, v73
    v_cvt_pk_bf16_f32 v74, 0, v74
    v_cvt_pk_bf16_f32 v75, 0, v75
    v_pk_mul_f32 v[68:69], v[68:69], s[36:37]
    v_pk_mul_f32 v[70:71], v[70:71], s[36:37]
    v_pk_mul_f32 v[72:73], v[72:73], s[36:37]
    v_pk_mul_f32 v[74:75], v[74:75], s[36:37]
    v_exp_f32 v68, v68
    v_exp_f32 v69, v69
    v_exp_f32 v70, v70
    v_exp_f32 v71, v71
    v_exp_f32 v72, v72
    v_exp_f32 v73, v73
    v_exp_f32 v74, v74
    v_exp_f32 v75, v75
    v_cvt_pk_bf16_f32 v60, v68, v69
    v_cvt_pk_bf16_f32 v61, v70, v71
    v_cvt_pk_bf16_f32 v62, v72, v73
    v_cvt_pk_bf16_f32 v63, v74, v75
    v_pk_add_f32 v[76:77], v[76:77], v[4:5] op_sel_hi:[1,0]
    v_pk_add_f32 v[78:79], v[78:79], v[4:5] op_sel_hi:[1,0]
    v_pk_add_f32 v[80:81], v[80:81], v[4:5] op_sel_hi:[1,0]
    v_pk_add_f32 v[82:83], v[82:83], v[4:5] op_sel_hi:[1,0]
    v_cvt_pk_bf16_f32 v76, 0, v76
    v_cvt_pk_bf16_f32 v77, 0, v77
    v_cvt_pk_bf16_f32 v78, 0, v78
    v_cvt_pk_bf16_f32 v79, 0, v79
    v_cvt_pk_bf16_f32 v80, 0, v80
    v_cvt_pk_bf16_f32 v81, 0, v81
    v_cvt_pk_bf16_f32 v82, 0, v82
    v_cvt_pk_bf16_f32 v83, 0, v83
    v_pk_mul_f32 v[76:77], v[76:77], s[36:37]
    v_pk_mul_f32 v[78:79], v[78:79], s[36:37]
    v_pk_mul_f32 v[80:81], v[80:81], s[36:37]
    v_pk_mul_f32 v[82:83], v[82:83], s[36:37]
    v_exp_f32 v76, v76
    v_exp_f32 v77, v77
    v_exp_f32 v78, v78
    v_exp_f32 v79, v79
    v_exp_f32 v80, v80
    v_exp_f32 v81, v81
    v_exp_f32 v82, v82
    v_exp_f32 v83, v83
    v_cvt_pk_bf16_f32 v64, v76, v77
    v_cvt_pk_bf16_f32 v65, v78, v79
    v_cvt_pk_bf16_f32 v66, v80, v81
    v_cvt_pk_bf16_f32 v67, v82, v83
    s_cmp_eq_u32 s66, 0
    s_cbranch_scc1 L_getq1
L_gotq1:
    v_mfma_f32_16x16x32_bf16 v[48:51], v[60:63], v[28:31], v[36:39]
    v_add_u32 v56, s38, v9
    v_mfma_f32_16x16x32_bf16 v[48:51], v[64:67], v[32:35], v[48:51]
    s_mov_b32 s54, s55
    s_mov_b32 s55, s56
    s_mov_b32 s56, s57
    s_mov_b32 s57, s58
    s_nop 4
    v_cvt_pk_bf16_f32 v48, 0, v48
    v_cvt_pk_bf16_f32 v49, 0, v49
    v_cvt_pk_bf16_f32 v50, 0, v50
    v_cvt_pk_bf16_f32 v51, 0, v51
    s_mov_b64 exec, s[60:61]
    ds_write2_b32 v56, v48, v49 offset0:0 offset1:4
    ds_write2_b32 v56, v50, v51 offset0:8 offset1:12
    s_mov_b64 exec, -1
    s_branch L_kloop
L_getq0:
    v_lshrrev_b32 v56, 4, v0
    v_lshlrev_b32 v56, 5, v56
    v_add_u32 v56, 135232, v56
L_q0_w:
    ds_read_b32 v3, v10 offset:12
    s_waitcnt lgkmcnt(0)
    v_readfirstlane_b32 s66, v3
    s_cmp_lg_u32 s66, 0
    s_cbranch_scc1 L_q0_g
    s_sleep 1
    s_branch L_q0_w
L_q0_g:
    ds_read_b128 v[28:31], v56
    ds_read_b128 v[32:35], v56 offset:16
    ds_read_b128 v[36:39], v10 offset:160
    s_waitcnt lgkmcnt(0)
    s_branch L_gotq0
L_getq1:
    v_lshrrev_b32 v56, 4, v0
    v_lshlrev_b32 v56, 5, v56
    v_add_u32 v56, 135232, v56
L_q1_w:
    ds_read_b32 v3, v10 offset:12
    s_waitcnt lgkmcnt(0)
    v_readfirstlane_b32 s66, v3
    s_cmp_lg_u32 s66, 0
    s_cbranch_scc1 L_q1_g
    s_sleep 1
    s_branch L_q1_w
L_q1_g:
    ds_read_b128 v[28:31], v56
    ds_read_b128 v[32:35], v56 offset:16
    ds_read_b128 v[36:39], v10 offset:160
    s_waitcnt lgkmcnt(0)
    s_branch L_gotq1
L_alt0:
    s_cmp_ge_u32 s62, 4
    s_cbranch_scc0 L_pre0
    buffer_load_dword v90, v12, s[8:11], s59 offen
    buffer_load_dword v90, v12, s[8:11], s59 offen
    buffer_load_dword v90, v12, s[8:11], s59 offen
    buffer_load_dword v90, v12, s[8:11], s59 offen
    s_branch L_back0
L_pre0:
    s_cmp_lg_u32 s62, 0
    s_cbranch_scc1 L_nx0_0
    buffer_load_dwordx4 a[64:67], v1, s[12:15], s25 offen offset:0 nt
    buffer_load_dwordx4 a[68:71], v1, s[12:15], s25 offen offset:1024 nt
    buffer_load_dwordx4 a[72:75], v1, s[12:15], s25 offen offset:2048 nt
    buffer_load_dwordx4 a[76:79], v1, s[12:15], s25 offen offset:3072 nt
    s_add_u32 s25, s25, 32768
    s_mov_b32 s62, 1
    s_branch L_back0
L_nx0_0:
    s_cmp_lg_u32 s62, 1
    s_cbranch_scc1 L_nx0_1
    buffer_load_dwordx4 a[80:83], v1, s[12:15], s25 offen offset:0 nt
    buffer_load_dwordx4 a[84:87], v1, s[12:15], s25 offen offset:1024 nt
    buffer_load_dwordx4 a[88:91], v1, s[12:15], s25 offen offset:2048 nt
    buffer_load_dwordx4 a[92:95], v1, s[12:15], s25 offen offset:3072 nt
    s_add_u32 s25, s25, 32768
    s_mov_b32 s62, 2
    s_branch L_back0
L_nx0_1:
    s_cmp_lg_u32 s62, 2
    s_cbranch_scc1 L_nx0_2
    buffer_load_dwordx4 a[96:99], v1, s[12:15], s25 offen offset:0 nt
    buffer_load_dwordx4 a[100:103], v1, s[12:15], s25 offen offset:1024 nt
    buffer_load_dwordx4 a[104:107], v1, s[12:15], s25 offen offset:2048 nt
    buffer_load_dwordx4 a[108:111], v1, s[12:15], s25 offen offset:3072 nt
    s_add_u32 s25, s25, 32768
    s_mov_b32 s62, 3
    s_branch L_back0
L_nx0_2:
    buffer_load_dwordx4 a[112:115], v1, s[12:15], s25 offen offset:0 nt
    buffer_load_dwordx4 a[116:119], v1, s[12:15], s25 offen offset:1024 nt
    buffer_load_dwordx4 a[120:123], v1, s[12:15], s25 offen offset:2048 nt
    buffer_load_dwordx4 a[124:127], v1, s[12:15], s25 offen offset:3072 nt
    s_add_u32 s25, s25, 32768
    s_mov_b32 s62, 4
    s_branch L_back0
L_alt1:
    s_cmp_ge_u32 s62, 4
    s_cbranch_scc0 L_pre1
    buffer_load_dword v90, v12, s[8:11], s59 offen
    buffer_load_dword v90, v12, s[8:11], s59 offen
    buffer_load_dword v90, v12, s[8:11], s59 offen
    buffer_load_dword v90, v12, s[8:11], s59 offen
    s_branch L_back1
L_pre1:
    s_cmp_lg_u32 s62, 0
    s_cbranch_scc1 L_nx1_0
    buffer_load_dwordx4 a[64:67], v1, s[12:15], s25 offen offset:0 nt
    buffer_load_dwordx4 a[68:71], v1, s[12:15], s25 offen offset:1024 nt
    buffer_load_dwordx4 a[72:75], v1, s[12:15], s25 offen offset:2048 nt
    buffer_load_dwordx4 a[76:79], v1, s[12:15], s25 offen offset:3072 nt
    s_add_u32 s25, s25, 32768
    s_mov_b32 s62, 1
    s_branch L_back1
L_nx1_0:
    s_cmp_lg_u32 s62, 1
    s_cbranch_scc1 L_nx1_1
    buffer_load_dwordx4 a[80:83], v1, s[12:15], s25 offen offset:0 nt
    buffer_load_dwordx4 a[84:87], v1, s[12:15], s25 offen offset:1024 nt
    buffer_load_dwordx4 a[88:91], v1, s[12:15], s25 offen offset:2048 nt
    buffer_load_dwordx4 a[92:95], v1, s[12:15], s25 offen offset:3072 nt
    s_add_u32 s25, s25, 32768
    s_mov_b32 s62, 2
    s_branch L_back1
L_nx1_1:
    s_cmp_lg_u32 s62, 2
    s_cbranch_scc1 L_nx1_2
    buffer_load_dwordx4 a[96:99], v1, s[12:15], s25 offen offset:0 nt
    buffer_load_dwordx4 a[100:103], v1, s[12:15], s25 offen offset:1024 nt
    buffer_load_dwordx4 a[104:107], v1, s[12:15], s25 offen offset:2048 nt
    buffer_load_dwordx4 a[108:111], v1, s[12:15], s25 offen offset:3072 nt
    s_add_u32 s25, s25, 32768
    s_mov_b32 s62, 3
    s_branch L_back1
L_nx1_2:
    buffer_load_dwordx4 a[112:115], v1, s[12:15], s25 offen offset:0 nt
    buffer_load_dwordx4 a[116:119], v1, s[12:15], s25 offen offset:1024 nt
    buffer_load_dwordx4 a[120:123], v1, s[12:15], s25 offen offset:2048 nt
    buffer_load_dwordx4 a[124:127], v1, s[12:15], s25 offen offset:3072 nt
    s_add_u32 s25, s25, 32768
    s_mov_b32 s62, 4
    s_branch L_back1
L_kdone:
L_fill:
    s_cmp_ge_u32 s62, 4
    s_cbranch_scc1 L_full
    s_cmp_lg_u32 s62, 0
    s_cbranch_scc1 L_nxf_0
    buffer_load_dwordx4 a[64:67], v1, s[12:15], s25 offen offset:0 nt
    buffer_load_dwordx4 a[68:71], v1, s[12:15], s25 offen offset:1024 nt
    buffer_load_dwordx4 a[72:75], v1, s[12:15], s25 offen offset:2048 nt
    buffer_load_dwordx4 a[76:79], v1, s[12:15], s25 offen offset:3072 nt
    s_add_u32 s25, s25, 32768
    s_mov_b32 s62, 1
    s_branch L_fill
L_nxf_0:
    s_cmp_lg_u32 s62, 1
    s_cbranch_scc1 L_nxf_1
    buffer_load_dwordx4 a[80:83], v1, s[12:15], s25 offen offset:0 nt
    buffer_load_dwordx4 a[84:87], v1, s[12:15], s25 offen offset:1024 nt
    buffer_load_dwordx4 a[88:91], v1, s[12:15], s25 offen offset:2048 nt
    buffer_load_dwordx4 a[92:95], v1, s[12:15], s25 offen offset:3072 nt
    s_add_u32 s25, s25, 32768
    s_mov_b32 s62, 2
    s_branch L_fill
L_nxf_1:
    s_cmp_lg_u32 s62, 2
    s_cbranch_scc1 L_nxf_2
    buffer_load_dwordx4 a[96:99], v1, s[12:15], s25 offen offset:0 nt
    buffer_load_dwordx4 a[100:103], v1, s[12:15], s25 offen offset:1024 nt
    buffer_load_dwordx4 a[104:107], v1, s[12:15], s25 offen offset:2048 nt
    buffer_load_dwordx4 a[108:111], v1, s[12:15], s25 offen offset:3072 nt
    s_add_u32 s25, s25, 32768
    s_mov_b32 s62, 3
    s_branch L_fill
L_nxf_2:
    buffer_load_dwordx4 a[112:115], v1, s[12:15], s25 offen offset:0 nt
    buffer_load_dwordx4 a[116:119], v1, s[12:15], s25 offen offset:1024 nt
    buffer_load_dwordx4 a[120:123], v1, s[12:15], s25 offen offset:2048 nt
    buffer_load_dwordx4 a[124:127], v1, s[12:15], s25 offen offset:3072 nt
    s_add_u32 s25, s25, 32768
    s_mov_b32 s62, 4
    s_branch L_fill
L_full:
    v_and_b32 v56, 15, v0
    v_lshrrev_b32 v57, 4, v0
    s_mov_b32 m0, s52
    s_nop 0
    buffer_load_dwordx4 v12, s[12:15], s25 offen offset:0 nt lds
    buffer_load_dwordx4 v13, s[12:15], s25 offen offset:1024 nt lds
    s_add_u32 m0, m0, 2048
    s_nop 0
    buffer_load_dwordx4 v14, s[12:15], s25 offen offset:0 nt lds
    buffer_load_dwordx4 v15, s[12:15], s25 offen offset:1024 nt lds
    s_add_u32 s25, s25, 32768
    s_mov_b32 m0, s53
    s_nop 0
    buffer_load_dwordx4 v12, s[12:15], s25 offen offset:0 nt lds
    buffer_load_dwordx4 v13, s[12:15], s25 offen offset:1024 nt lds
    s_add_u32 m0, m0, 2048
    s_nop 0
    buffer_load_dwordx4 v14, s[12:15], s25 offen offset:0 nt lds
    buffer_load_dwordx4 v15, s[12:15], s25 offen offset:1024 nt lds
    s_add_u32 s25, s25, 32768
    s_lshl_b32 s38, s3, 6
    s_add_u32 s38, s38, 114688
    v_lshl_add_u32 v9, v57, 4, s38
    v_add_u32 v16, 0, v57
    v_xor_b32 v16, v16, v56
    v_lshlrev_b32 v16, 4, v16
    v_lshl_add_u32 v16, v57, 8, v16
    s_add_u32 s38, s52, 0
    v_add_u32 v16, s38, v16
    v_add_u32 v17, 4, v57
    v_xor_b32 v17, v17, v56
    v_lshlrev_b32 v17, 4, v17
    v_lshl_add_u32 v17, v57, 8, v17
    s_add_u32 s38, s52, 1024
    v_add_u32 v17, s38, v17
    v_add_u32 v18, 8, v57
    v_xor_b32 v18, v18, v56
    v_lshlrev_b32 v18, 4, v18
    v_lshl_add_u32 v18, v57, 8, v18
    v_and_b32 v58, 4, v56
    v_lshlrev_b32 v58, 8, v58
    s_add_u32 s38, s52, 2048
    v_add3_u32 v18, v18, v58, s38
    v_add_u32 v19, 12, v57
    v_xor_b32 v19, v19, v56
    v_lshlrev_b32 v19, 4, v19
    v_lshl_add_u32 v19, v57, 8, v19
    v_and_b32 v58, 4, v56
    v_lshlrev_b32 v58, 8, v58
    s_add_u32 s38, s52, 2048
    v_add3_u32 v19, v19, v58, s38
    s_waitcnt lgkmcnt(0)
    s_barrier
    ds_read_b128 v[48:51], v9
    s_waitcnt lgkmcnt(0)
    ds_read_b128 v[84:87], v9 offset:512
    v_perm_b32 v68, v48, v48, v24
    v_perm_b32 v69, v48, v48, v25
    v_perm_b32 v70, v48, v48, v26
    v_perm_b32 v71, v48, v48, v27
    v_perm_b32 v72, v49, v49, v24
    v_perm_b32 v73, v49, v49, v25
    v_perm_b32 v74, v49, v49, v26
    v_perm_b32 v75, v49, v49, v27
    v_perm_b32 v76, v50, v50, v24
    v_perm_b32 v77, v50, v50, v25
    v_perm_b32 v78, v50, v50, v26
    v_perm_b32 v79, v50, v50, v27
    v_perm_b32 v80, v51, v51, v24
    v_perm_b32 v81, v51, v51, v25
    v_perm_b32 v82, v51, v51, v26
    v_perm_b32 v83, v51, v51, v27
    v_add_f32 v2, v2, v48
    v_add_f32 v2, v2, v49
    v_add_f32 v2, v2, v50
    v_add_f32 v2, v2, v51
    s_waitcnt vmcnt(20)
    v_mfma_f32_16x16x32_bf16 v[40:43], v[68:71], a[64:67], v[40:43]
    v_mfma_f32_16x16x32_bf16 v[40:43], v[72:75], a[68:71], v[40:43]
    v_mfma_f32_16x16x32_bf16 v[40:43], v[76:79], a[72:75], v[40:43]
    v_mfma_f32_16x16x32_bf16 v[40:43], v[80:83], a[76:79], v[40:43]
    buffer_load_dwordx4 a[64:67], v1, s[12:15], s25 offen offset:0 nt
    buffer_load_dwordx4 a[68:71], v1, s[12:15], s25 offen offset:1024 nt
    buffer_load_dwordx4 a[72:75], v1, s[12:15], s25 offen offset:2048 nt
    buffer_load_dwordx4 a[76:79], v1, s[12:15], s25 offen offset:3072 nt
    s_add_u32 s25, s25, 32768
    s_waitcnt lgkmcnt(0)
    ds_read_b128 v[48:51], v9 offset:1024
    v_perm_b32 v68, v84, v84, v24
    v_perm_b32 v69, v84, v84, v25
    v_perm_b32 v70, v84, v84, v26
    v_perm_b32 v71, v84, v84, v27
    v_perm_b32 v72, v85, v85, v24
    v_perm_b32 v73, v85, v85, v25
    v_perm_b32 v74, v85, v85, v26
    v_perm_b32 v75, v85, v85, v27
    v_perm_b32 v76, v86, v86, v24
    v_perm_b32 v77, v86, v86, v25
    v_perm_b32 v78, v86, v86, v26
    v_perm_b32 v79, v86, v86, v27
    v_perm_b32 v80, v87, v87, v24
    v_perm_b32 v81, v87, v87, v25
    v_perm_b32 v82, v87, v87, v26
    v_perm_b32 v83, v87, v87, v27
    v_add_f32 v2, v2, v84
    v_add_f32 v2, v2, v85
    v_add_f32 v2, v2, v86
    v_add_f32 v2, v2, v87
    s_waitcnt vmcnt(20)
    v_mfma_f32_16x16x32_bf16 v[40:43], v[68:71], a[80:83], v[40:43]
    v_mfma_f32_16x16x32_bf16 v[40:43], v[72:75], a[84:87], v[40:43]
    v_mfma_f32_16x16x32_bf16 v[40:43], v[76:79], a[88:91], v[40:43]
    v_mfma_f32_16x16x32_bf16 v[40:43], v[80:83], a[92:95], v[40:43]
    buffer_load_dwordx4 a[80:83], v1, s[12:15], s25 offen offset:0 nt
    buffer_load_dwordx4 a[84:87], v1, s[12:15], s25 offen offset:1024 nt
    buffer_load_dwordx4 a[88:91], v1, s[12:15], s25 offen offset:2048 nt
    buffer_load_dwordx4 a[92:95], v1, s[12:15], s25 offen offset:3072 nt
    s_add_u32 s25, s25, 32768
    s_waitcnt lgkmcnt(0)
    ds_read_b128 v[84:87], v9 offset:1536
    v_perm_b32 v68, v48, v48, v24
    v_perm_b32 v69, v48, v48, v25
    v_perm_b32 v70, v48, v48, v26
    v_perm_b32 v71, v48, v48, v27
    v_perm_b32 v72, v49, v49, v24
    v_perm_b32 v73, v49, v49, v25
    v_perm_b32 v74, v49, v49, v26
    v_perm_b32 v75, v49, v49, v27
    v_perm_b32 v76, v50, v50, v24
    v_perm_b32 v77, v50, v50, v25
    v_perm_b32 v78, v50, v50, v26
    v_perm_b32 v79, v50, v50, v27
    v_perm_b32 v80, v51, v51, v24
    v_perm_b32 v81, v51, v51, v25
    v_perm_b32 v82, v51, v51, v26
    v_perm_b32 v83, v51, v51, v27
    v_add_f32 v2, v2, v48
    v_add_f32 v2, v2, v49
    v_add_f32 v2, v2, v50
    v_add_f32 v2, v2, v51
    s_waitcnt vmcnt(20)
    v_mfma_f32_16x16x32_bf16 v[40:43], v[68:71], a[96:99], v[40:43]
    v_mfma_f32_16x16x32_bf16 v[40:43], v[72:75], a[100:103], v[40:43]
    v_mfma_f32_16x16x32_bf16 v[40:43], v[76:79], a[104:107], v[40:43]
    v_mfma_f32_16x16x32_bf16 v[40:43], v[80:83], a[108:111], v[40:43]
    s_waitcnt lgkmcnt(0)
    ds_read_b128 v[48:51], v9 offset:2048
    v_perm_b32 v68, v84, v84, v24
    v_perm_b32 v69, v84, v84, v25
    v_perm_b32 v70, v84, v84, v26
    v_perm_b32 v71, v84, v84, v27
    v_perm_b32 v72, v85, v85, v24
    v_perm_b32 v73, v85, v85, v25
    v_perm_b32 v74, v85, v85, v26
    v_perm_b32 v75, v85, v85, v27
    v_perm_b32 v76, v86, v86, v24
    v_perm_b32 v77, v86, v86, v25
    v_perm_b32 v78, v86, v86, v26
    v_perm_b32 v79, v86, v86, v27
    v_perm_b32 v80, v87, v87, v24
    v_perm_b32 v81, v87, v87, v25
    v_perm_b32 v82, v87, v87, v26
    v_perm_b32 v83, v87, v87, v27
    v_add_f32 v2, v2, v84
    v_add_f32 v2, v2, v85
    v_add_f32 v2, v2, v86
    v_add_f32 v2, v2, v87
    s_waitcnt vmcnt(16)
    v_mfma_f32_16x16x32_bf16 v[40:43], v[68:71], a[112:115], v[40:43]
    v_mfma_f32_16x16x32_bf16 v[40:43], v[72:75], a[116:119], v[40:43]
    v_mfma_f32_16x16x32_bf16 v[40:43], v[76:79], a[120:123], v[40:43]
    v_mfma_f32_16x16x32_bf16 v[40:43], v[80:83], a[124:127], v[40:43]
    v_add_u32 v9, 2048, v9
    s_mov_b32 s26, 6
    .p2align 6
L_vloop:
    s_waitcnt vmcnt(12) lgkmcnt(0)
    ds_read_b128 v[92:95], v16 offset:0
    ds_read_b128 v[96:99], v17 offset:0
    ds_read_b128 v[100:103], v18 offset:0
    ds_read_b128 v[104:107], v19 offset:0
    ds_read_b128 v[84:87], v9 offset:512
    v_perm_b32 v68, v48, v48, v24
    v_perm_b32 v69, v48, v48, v25
    v_perm_b32 v70, v48, v48, v26
    v_perm_b32 v71, v48, v48, v27
    v_perm_b32 v72, v49, v49, v24
    v_perm_b32 v73, v49, v49, v25
    v_perm_b32 v74, v49, v49, v26
    v_perm_b32 v75, v49, v49, v27
    v_perm_b32 v76, v50, v50, v24
    v_perm_b32 v77, v50, v50, v25
    v_perm_b32 v78, v50, v50, v26
    v_perm_b32 v79, v50, v50, v27
    v_perm_b32 v80, v51, v51, v24
    v_perm_b32 v81, v51, v51, v25
    v_perm_b32 v82, v51, v51, v26
    v_perm_b32 v83, v51, v51, v27
    v_add_f32 v2, v2, v48
    v_add_f32 v2, v2, v49
    v_add_f32 v2, v2, v50
    v_add_f32 v2, v2, v51
    s_waitcnt lgkmcnt(1)
    s_mov_b32 m0, s52
    s_nop 0
    buffer_load_dwordx4 v12, s[12:15], s25 offen offset:0 nt lds
    buffer_load_dwordx4 v13, s[12:15], s25 offen offset:1024 nt lds
    s_add_u32 m0, m0, 2048
    s_nop 0
    buffer_load_dwordx4 v14, s[12:15], s25 offen offset:0 nt lds
    buffer_load_dwordx4 v15, s[12:15], s25 offen offset:1024 nt lds
    s_add_u32 s25, s25, 32768
    v_mfma_f32_16x16x32_bf16 v[40:43], v[68:71], v[92:95], v[40:43]
    v_mfma_f32_16x16x32_bf16 v[40:43], v[72:75], v[96:99], v[40:43]
    v_mfma_f32_16x16x32_bf16 v[40:43], v[76:79], v[100:103], v[40:43]
    v_mfma_f32_16x16x32_bf16 v[40:43], v[80:83], v[104:107], v[40:43]
    s_waitcnt vmcnt(12) lgkmcnt(0)
    ds_read_b128 v[92:95], v16 offset:4096
    ds_read_b128 v[96:99], v17 offset:4096
    ds_read_b128 v[100:103], v18 offset:4096
    ds_read_b128 v[104:107], v19 offset:4096
    ds_read_b128 v[48:51], v9 offset:1024
    v_perm_b32 v68, v84, v84, v24
    v_perm_b32 v69, v84, v84, v25
    v_perm_b32 v70, v84, v84, v26
    v_perm_b32 v71, v84, v84, v27
    v_perm_b32 v72, v85, v85, v24
    v_perm_b32 v73, v85, v85, v25
    v_perm_b32 v74, v85, v85, v26
    v_perm_b32 v75, v85, v85, v27
    v_perm_b32 v76, v86, v86, v24
    v_perm_b32 v77, v86, v86, v25
    v_perm_b32 v78, v86, v86, v26
    v_perm_b32 v79, v86, v86, v27
    v_perm_b32 v80, v87, v87, v24
    v_perm_b32 v81, v87, v87, v25
    v_perm_b32 v82, v87, v87, v26
    v_perm_b32 v83, v87, v87, v27
    v_add_f32 v2, v2, v84
    v_add_f32 v2, v2, v85
    v_add_f32 v2, v2, v86
    v_add_f32 v2, v2, v87
    s_waitcnt lgkmcnt(1)
    s_mov_b32 m0, s53
    s_nop 0
    buffer_load_dwordx4 v12, s[12:15], s25 offen offset:0 nt lds
    buffer_load_dwordx4 v13, s[12:15], s25 offen offset:1024 nt lds
    s_add_u32 m0, m0, 2048
    s_nop 0
    buffer_load_dwordx4 v14, s[12:15], s25 offen offset:0 nt lds
    buffer_load_dwordx4 v15, s[12:15], s25 offen offset:1024 nt lds
    s_add_u32 s25, s25, 32768
    v_mfma_f32_16x16x32_bf16 v[40:43], v[68:71], v[92:95], v[40:43]
    v_mfma_f32_16x16x32_bf16 v[40:43], v[72:75], v[96:99], v[40:43]
    v_mfma_f32_16x16x32_bf16 v[40:43], v[76:79], v[100:103], v[40:43]
    v_mfma_f32_16x16x32_bf16 v[40:43], v[80:83], v[104:107], v[40:43]
    s_waitcnt lgkmcnt(0)
    ds_read_b128 v[84:87], v9 offset:1536
    v_perm_b32 v68, v48, v48, v24
    v_perm_b32 v69, v48, v48, v25
    v_perm_b32 v70, v48, v48, v26
    v_perm_b32 v71, v48, v48, v27
    v_perm_b32 v72, v49, v49, v24
    v_perm_b32 v73, v49, v49, v25
    v_perm_b32 v74, v49, v49, v26
    v_perm_b32 v75, v49, v49, v27
    v_perm_b32 v76, v50, v50, v24
    v_perm_b32 v77, v50, v50, v25
    v_perm_b32 v78, v50, v50, v26
    v_perm_b32 v79, v50, v50, v27
    v_perm_b32 v80, v51, v51, v24
    v_perm_b32 v81, v51, v51, v25
    v_perm_b32 v82, v51, v51, v26
    v_perm_b32 v83, v51, v51, v27
    v_add_f32 v2, v2, v48
    v_add_f32 v2, v2, v49
    v_add_f32 v2, v2, v50
    v_add_f32 v2, v2, v51
    s_waitcnt vmcnt(12)
    v_mfma_f32_16x16x32_bf16 v[40:43], v[68:71], a[64:67], v[40:43]
    v_mfma_f32_16x16x32_bf16 v[40:43], v[72:75], a[68:71], v[40:43]
    v_mfma_f32_16x16x32_bf16 v[40:43], v[76:79], a[72:75], v[40:43]
    v_mfma_f32_16x16x32_bf16 v[40:43], v[80:83], a[76:79], v[40:43]
    buffer_load_dwordx4 a[64:67], v1, s[12:15], s25 offen offset:0 nt
    buffer_load_dwordx4 a[68:71], v1, s[12:15], s25 offen offset:1024 nt
    buffer_load_dwordx4 a[72:75], v1, s[12:15], s25 offen offset:2048 nt
    buffer_load_dwordx4 a[76:79], v1, s[12:15], s25 offen offset:3072 nt
    s_add_u32 s25, s25, 32768
    s_waitcnt lgkmcnt(0)
    ds_read_b128 v[48:51], v9 offset:2048
    v_perm_b32 v68, v84, v84, v24
    v_perm_b32 v69, v84, v84, v25
    v_perm_b32 v70, v84, v84, v26
    v_perm_b32 v71, v84, v84, v27
    v_perm_b32 v72, v85, v85, v24
    v_perm_b32 v73, v85, v85, v25
    v_perm_b32 v74, v85, v85, v26
    v_perm_b32 v75, v85, v85, v27
    v_perm_b32 v76, v86, v86, v24
    v_perm_b32 v77, v86, v86, v25
    v_perm_b32 v78, v86, v86, v26
    v_perm_b32 v79, v86, v86, v27
    v_perm_b32 v80, v87, v87, v24
    v_perm_b32 v81, v87, v87, v25
    v_perm_b32 v82, v87, v87, v26
    v_perm_b32 v83, v87, v87, v27
    v_add_f32 v2, v2, v84
    v_add_f32 v2, v2, v85
    v_add_f32 v2, v2, v86
    v_add_f32 v2, v2, v87
    s_waitcnt vmcnt(12)
    v_mfma_f32_16x16x32_bf16 v[40:43], v[68:71], a[80:83], v[40:43]
    v_mfma_f32_16x16x32_bf16 v[40:43], v[72:75], a[84:87], v[40:43]
    v_mfma_f32_16x16x32_bf16 v[40:43], v[76:79], a[88:91], v[40:43]
    v_mfma_f32_16x16x32_bf16 v[40:43], v[80:83], a[92:95], v[40:43]
    buffer_load_dwordx4 a[80:83], v1, s[12:15], s25 offen offset:0 nt
    buffer_load_dwordx4 a[84:87], v1, s[12:15], s25 offen offset:1024 nt
    buffer_load_dwordx4 a[88:91], v1, s[12:15], s25 offen offset:2048 nt
    buffer_load_dwordx4 a[92:95], v1, s[12:15], s25 offen offset:3072 nt
    s_add_u32 s25, s25, 32768
    v_add_u32 v9, 2048, v9
    s_mov_b64 exec, 1
    ds_add_u32 v10, v11
    s_mov_b64 exec, -1
    s_sub_u32 s26, s26, 1
    s_cmp_lg_u32 s26, 0
    s_cbranch_scc1 L_vloop
    s_waitcnt vmcnt(12) lgkmcnt(0)
    ds_read_b128 v[92:95], v16 offset:0
    ds_read_b128 v[96:99], v17 offset:0
    ds_read_b128 v[100:103], v18 offset:0
    ds_read_b128 v[104:107], v19 offset:0
    ds_read_b128 v[84:87], v9 offset:512
    v_perm_b32 v68, v48, v48, v24
    v_perm_b32 v69, v48, v48, v25
    v_perm_b32 v70, v48, v48, v26
    v_perm_b32 v71, v48, v48, v27
    v_perm_b32 v72, v49, v49, v24
    v_perm_b32 v73, v49, v49, v25
    v_perm_b32 v74, v49, v49, v26
    v_perm_b32 v75, v49, v49, v27
    v_perm_b32 v76, v50, v50, v24
    v_perm_b32 v77, v50, v50, v25
    v_perm_b32 v78, v50, v50, v26
    v_perm_b32 v79, v50, v50, v27
    v_perm_b32 v80, v51, v51, v24
    v_perm_b32 v81, v51, v51, v25
    v_perm_b32 v82, v51, v51, v26
    v_perm_b32 v83, v51, v51, v27
    v_add_f32 v2, v2, v48
    v_add_f32 v2, v2, v49
    v_add_f32 v2, v2, v50
    v_add_f32 v2, v2, v51
    s_waitcnt lgkmcnt(1)
    v_mfma_f32_16x16x32_bf16 v[40:43], v[68:71], v[92:95], v[40:43]
    v_mfma_f32_16x16x32_bf16 v[40:43], v[72:75], v[96:99], v[40:43]
    v_mfma_f32_16x16x32_bf16 v[40:43], v[76:79], v[100:103], v[40:43]
    v_mfma_f32_16x16x32_bf16 v[40:43], v[80:83], v[104:107], v[40:43]
    s_waitcnt vmcnt(8) lgkmcnt(0)
    ds_read_b128 v[92:95], v16 offset:4096
    ds_read_b128 v[96:99], v17 offset:4096
    ds_read_b128 v[100:103], v18 offset:4096
    ds_read_b128 v[104:107], v19 offset:4096
    ds_read_b128 v[48:51], v9 offset:1024
    v_perm_b32 v68, v84, v84, v24
    v_perm_b32 v69, v84, v84, v25
    v_perm_b32 v70, v84, v84, v26
    v_perm_b32 v71, v84, v84, v27
    v_perm_b32 v72, v85, v85, v24
    v_perm_b32 v73, v85, v85, v25
    v_perm_b32 v74, v85, v85, v26
    v_perm_b32 v75, v85, v85, v27
    v_perm_b32 v76, v86, v86, v24
    v_perm_b32 v77, v86, v86, v25
    v_perm_b32 v78, v86, v86, v26
    v_perm_b32 v79, v86, v86, v27
    v_perm_b32 v80, v87, v87, v24
    v_perm_b32 v81, v87, v87, v25
    v_perm_b32 v82, v87, v87, v26
    v_perm_b32 v83, v87, v87, v27
    v_add_f32 v2, v2, v84
    v_add_f32 v2, v2, v85
    v_add_f32 v2, v2, v86
    v_add_f32 v2, v2, v87
    s_waitcnt lgkmcnt(1)
    v_mfma_f32_16x16x32_bf16 v[40:43], v[68:71], v[92:95], v[40:43]
    v_mfma_f32_16x16x32_bf16 v[40:43], v[72:75], v[96:99], v[40:43]
    v_mfma_f32_16x16x32_bf16 v[40:43], v[76:79], v[100:103], v[40:43]
    v_mfma_f32_16x16x32_bf16 v[40:43], v[80:83], v[104:107], v[40:43]
    s_waitcnt lgkmcnt(0)
    ds_read_b128 v[84:87], v9 offset:1536
    v_perm_b32 v68, v48, v48, v24
    v_perm_b32 v69, v48, v48, v25
    v_perm_b32 v70, v48, v48, v26
    v_perm_b32 v71, v48, v48, v27
    v_perm_b32 v72, v49, v49, v24
    v_perm_b32 v73, v49, v49, v25
    v_perm_b32 v74, v49, v49, v26
    v_perm_b32 v75, v49, v49, v27
    v_perm_b32 v76, v50, v50, v24
    v_perm_b32 v77, v50, v50, v25
    v_perm_b32 v78, v50, v50, v26
    v_perm_b32 v79, v50, v50, v27
    v_perm_b32 v80, v51, v51, v24
    v_perm_b32 v81, v51, v51, v25
    v_perm_b32 v82, v51, v51, v26
    v_perm_b32 v83, v51, v51, v27
    v_add_f32 v2, v2, v48
    v_add_f32 v2, v2, v49
    v_add_f32 v2, v2, v50
    v_add_f32 v2, v2, v51
    s_waitcnt vmcnt(4)
    v_mfma_f32_16x16x32_bf16 v[40:43], v[68:71], a[64:67], v[40:43]
    v_mfma_f32_16x16x32_bf16 v[40:43], v[72:75], a[68:71], v[40:43]
    v_mfma_f32_16x16x32_bf16 v[40:43], v[76:79], a[72:75], v[40:43]
    v_mfma_f32_16x16x32_bf16 v[40:43], v[80:83], a[76:79], v[40:43]
    s_waitcnt lgkmcnt(0)
    ds_read_b128 v[48:51], v9 offset:2048
    v_perm_b32 v68, v84, v84, v24
    v_perm_b32 v69, v84, v84, v25
    v_perm_b32 v70, v84, v84, v26
    v_perm_b32 v71, v84, v84, v27
    v_perm_b32 v72, v85, v85, v24
    v_perm_b32 v73, v85, v85, v25
    v_perm_b32 v74, v85, v85, v26
    v_perm_b32 v75, v85, v85, v27
    v_perm_b32 v76, v86, v86, v24
    v_perm_b32 v77, v86, v86, v25
    v_perm_b32 v78, v86, v86, v26
    v_perm_b32 v79, v86, v86, v27
    v_perm_b32 v80, v87, v87, v24
    v_perm_b32 v81, v87, v87, v25
    v_perm_b32 v82, v87, v87, v26
    v_perm_b32 v83, v87, v87, v27
    v_add_f32 v2, v2, v84
    v_add_f32 v2, v2, v85
    v_add_f32 v2, v2, v86
    v_add_f32 v2, v2, v87
    s_waitcnt vmcnt(0)
    v_mfma_f32_16x16x32_bf16 v[40:43], v[68:71], a[80:83], v[40:43]
    v_mfma_f32_16x16x32_bf16 v[40:43], v[72:75], a[84:87], v[40:43]
    v_mfma_f32_16x16x32_bf16 v[40:43], v[76:79], a[88:91], v[40:43]
    v_mfma_f32_16x16x32_bf16 v[40:43], v[80:83], a[92:95], v[40:43]
    v_mfma_f32_16x16x4_f32 v[44:47], v6, v2, 0
    v_and_b32 v59, 15, v0
    v_mov_b32 v57, v59
    v_lshrrev_b32 v58, 4, v0
    v_lshlrev_b32 v56, 5, v57
    v_lshl_add_u32 v56, v58, 4, v56
    s_lshl_b32 s38, s3, 9
    s_add_u32 s38, s38, 131072
    v_add_u32 v56, s38, v56
    s_lshl_b32 s38, s3, 2
    s_add_u32 s38, s38, 135168
    v_mov_b32 v59, s38
    s_mov_b32 exec_hi, 0
    ds_write_b128 v56, v[40:43]
    s_mov_b64 exec, 1
    ds_write_b32 v59, v44
    ds_add_u32 v10, v11 offset:4
    s_mov_b64 exec, -1
    s_cmp_lg_u32 s3, 0
    s_cbranch_scc1 L_done
    v_lshlrev_b32 v56, 3, v0
    v_add_u32 v56, 131072, v56
    s_lshl_b32 s38, s2, 10
    v_lshl_add_u32 v57, v0, 4, s38
    v_xor_b32 v3, 1024, v57
    s_lshr_b32 s39, s2, 5
    s_lshl_b32 s39, s39, 5
    v_mov_b32 v59, s39
    s_xor_b32 s48, s2, 1
    s_and_b32 s48, s48, 31
    s_mov_b32 s49, 0
    v_mov_b32 v64, 135168
    v_mov_b32 v71, 1
    s_lshl_b32 s38, s24, 8
    v_lshl_add_u32 v58, v0, 2, s38
    global_load_dword v62, v59, s[30:31] sc0 sc1
    s_waitcnt vmcnt(0)
    v_readfirstlane_b32 s50, v62
    s_lshr_b32 s50, s50, s48
    s_and_b32 s50, s50, 1
L_wait:
    ds_read_b64 v[60:61], v10
    s_waitcnt lgkmcnt(0)
    v_readfirstlane_b32 s38, v61
    v_readfirstlane_b32 s39, v60
    s_cmp_ge_u32 s38, 8
    s_cbranch_scc1 L_all
    s_cmp_lt_u32 s39, 45
    s_cbranch_scc1 L_longnap
    s_cmp_gt_u32 s50, s49
    s_cbranch_scc0 L_nap
    global_load_dwordx4 v[72:75], v3, s[32:33] sc0 sc1
    s_waitcnt vmcnt(0)
    v_cmp_eq_u32 vcc, 1, v75
    s_nop 1
    s_cmp_eq_u64 vcc, -1
    s_cselect_b32 s49, 1, 0
    s_branch L_wait
L_longnap:
    s_sleep 8
L_nap:
    s_sleep 1
    s_branch L_wait
L_all:
    ds_read_b64 v[92:93], v56 offset:0
    ds_read_b64 v[94:95], v56 offset:512
    ds_read_b64 v[96:97], v56 offset:1024
    ds_read_b64 v[98:99], v56 offset:1536
    ds_read_b64 v[100:101], v56 offset:2048
    ds_read_b64 v[102:103], v56 offset:2560
    ds_read_b64 v[104:105], v56 offset:3072
    ds_read_b64 v[106:107], v56 offset:3584
    ds_read_b128 v[108:111], v64 offset:0
    ds_read_b128 v[112:115], v64 offset:16
    s_waitcnt lgkmcnt(0)
    v_add_f32 v68, v92, v94
    v_add_f32 v69, v93, v95
    v_add_f32 v70, v108, v109
    v_add_f32 v68, v68, v96
    v_add_f32 v69, v69, v97
    v_add_f32 v70, v70, v110
    v_add_f32 v68, v68, v98
    v_add_f32 v69, v69, v99
    v_add_f32 v70, v70, v111
    v_add_f32 v68, v68, v100
    v_add_f32 v69, v69, v101
    v_add_f32 v70, v70, v112
    v_add_f32 v68, v68, v102
    v_add_f32 v69, v69, v103
    v_add_f32 v70, v70, v113
    v_add_f32 v68, v68, v104
    v_add_f32 v69, v69, v105
    v_add_f32 v70, v70, v114
    v_add_f32 v68, v68, v106
    v_add_f32 v69, v69, v107
    v_add_f32 v70, v70, v115
    s_cmp_lg_u32 s49, 0
    s_cbranch_scc1 L_comb
    global_store_dwordx4 v57, v[68:71], s[32:33] sc0 sc1
    s_waitcnt vmcnt(0)
    s_cmp_lg_u32 s50, 0
    s_cbranch_scc1 L_look
    global_load_dword v62, v59, s[30:31] sc0 sc1
    s_waitcnt vmcnt(0)
    v_readfirstlane_b32 s50, v62
    s_lshr_b32 s50, s50, s48
    s_and_b32 s50, s50, 1
    s_cmp_eq_u32 s50, 0
    s_cbranch_scc1 L_done
L_look:
    global_load_dwordx4 v[72:75], v3, s[32:33] sc0 sc1
    s_waitcnt vmcnt(0)
    v_cmp_eq_u32 vcc, 1, v75
    s_nop 1
    s_cmp_eq_u64 vcc, -1
    s_cselect_b32 s49, 1, 0
    s_cbranch_scc0 L_done
L_comb:
    v_add_f32 v70, v70, v74
    v_add_f32 v68, v68, v72
    v_add_f32 v70, 0x358637bd, v70
    v_add_f32 v69, v69, v73
    v_div_scale_f32 v92, s[44:45], v70, v70, v68
    v_div_scale_f32 v100, s[44:45], v70, v70, v69
    v_rcp_f32 v93, v92
    v_rcp_f32 v101, v100
    v_div_scale_f32 v94, s[40:41], v68, v70, v68
    v_div_scale_f32 v102, s[42:43], v69, v70, v69
    v_fma_f32 v95, -v92, v93, 1.0
    v_fma_f32 v103, -v100, v101, 1.0
    v_fma_f32 v93, v95, v93, v93
    v_fma_f32 v101, v103, v101, v101
    v_mul_f32 v95, v94, v93
    v_mul_f32 v103, v102, v101
    v_fma_f32 v96, -v92, v95, v94
    v_fma_f32 v104, -v100, v103, v102
    v_fma_f32 v95, v96, v93, v95
    v_fma_f32 v103, v104, v101, v103
    v_fma_f32 v92, -v92, v95, v94
    v_fma_f32 v100, -v100, v103, v102
    s_mov_b64 vcc, s[40:41]
    s_nop 3
    v_div_fmas_f32 v92, v92, v93, v95
    v_div_fixup_f32 v68, v92, v70, v68
    s_mov_b64 vcc, s[42:43]
    s_nop 3
    v_div_fmas_f32 v100, v100, v101, v103
    v_div_fixup_f32 v69, v100, v70, v69
    v_cvt_pk_bf16_f32 v68, v68, v69
    global_store_dword v58, v68, s[28:29]
L_done:
    s_endpgm
.section .rodata,"a"
.p2align 6
.amdhsa_kernel standalone__linear_kernel_rfa__decode_kernel
  .amdhsa_next_free_vgpr 252
  .amdhsa_next_free_sgpr 72
  .amdhsa_accum_offset 124
  .amdhsa_group_segment_fixed_size 0
  .amdhsa_kernarg_size 56
  .amdhsa_user_sgpr_count 2
  .amdhsa_user_sgpr_kernarg_segment_ptr 1
  .amdhsa_system_sgpr_workgroup_id_x 1
  .amdhsa_float_denorm_mode_32 3
.end_amdhsa_kernel
```
